```python
import torch

def _softmax(x, axis=-1):
    return torch.softmax(x, dim=axis)
def _gelu(x):
    return torch.nn.functional.gelu(x, approximate="tanh")
def _silu(x):
    return torch.nn.functional.silu(x)
def _sigmoid(x):
    return torch.sigmoid(x)
def _layernorm(x, axis=-1, eps=1e-5):
    m = x.mean(dim=axis, keepdim=True)
    v = x.var(dim=axis, keepdim=True, unbiased=False)
    return (x - m) / torch.sqrt(v + eps)
def _scatter_add(tgt, idx, src, axis=0):
    return tgt.clone().index_add_(axis, idx, src)
def _segment_sum(src, seg, n):
    out = torch.zeros((n,) + src.shape[1:], dtype=src.dtype)
    return out.index_add_(0, seg, src)
def _pad(x, pw):
    flat = tuple(v for pair in reversed(pw) for v in pair)
    return torch.nn.functional.pad(x, flat)

kernel_name = 'gather_scatter__edge_featured_mpnn_egc__graph'

def setup_inputs():

    _w = (lambda a: (lambda t: t.to(torch.bfloat16) if t.is_floating_point() else t)(torch.as_tensor(a)))
    N, deg, D, De = 10000, 32, 128, max(16, 1)
    E = N * deg
    return {
        "x": _w((lambda *s: torch.randn(*s, dtype=torch.bfloat16) * 0.2)(N, D)),
        "e_attr": _w((lambda *s: torch.randn(*s, dtype=torch.bfloat16) * 0.2)(E, De)),
        "src": _w((lambda lo, hi, *s: torch.randint(lo, hi, s))(0, N, E).to(torch.int64)),
        "dst": _w((lambda lo, hi, *s: torch.randint(lo, hi, s))(0, N, E).to(torch.int64)),
        "u_w": _w((lambda *s: torch.randn(*s, dtype=torch.bfloat16) * 0.05)(D, D)),
        "v_w": _w((lambda *s: torch.randn(*s, dtype=torch.bfloat16) * 0.05)(D, D)),
        "g_w": _w((lambda *s: torch.randn(*s, dtype=torch.bfloat16) * 0.2)(2 * D + De, D)),
    }

def reference(x, e_attr, src, dst, u_w, v_w, g_w):
    N, D = x.shape
    g_in = torch.concatenate([x[dst], x[src], e_attr], axis=-1)
    eta = _sigmoid(g_in @ g_w)
    hv = x @ v_w
    msg = eta * hv[src]
    agg = _segment_sum(msg, dst, N)
    return _silu(x @ u_w + agg)
```

```asm
; @launch kernel=prep_kernel grid=(223,1,1) block=(640,1,1) lds=133120
; @launch kernel=gather_scatter__edge_featured_mpnn_egc__graph_kernel grid=(768,1,1) block=(256,1,1) lds=49920
.amdgcn_target "amdgcn-amd-amdhsa--gfx950"
.text
.globl prep_kernel
.p2align 8
.type prep_kernel,@function
prep_kernel:
    s_cmp_ge_u32 s2, 223
    s_cbranch_scc1 P_end
    s_cmp_ge_u32 s2, 222
    s_cbranch_scc1 P_weights
    s_cmp_ge_u32 s2, 64
    s_cbranch_scc1 P_gemm
    s_load_dwordx4 s[4:7], s[0:1], 16
    s_load_dwordx2 s[8:9], s[0:1], 72
    v_lshlrev_b32 v2, 4, v0
    v_mov_b32 v4, 0
    v_mov_b32 v5, 0
    v_mov_b32 v6, 0
    v_mov_b32 v7, 0
    ds_write_b128 v2, v[4:7]
    ds_write_b128 v2, v[4:7] offset:10240
    v_lshlrev_b32 v1, 4, v0
    s_mul_i32 s3, s2, 20000
    s_mov_b32 s20, 214749
    s_movk_i32 s21, 625
    s_movk_i32 s28, -16
    s_movk_i32 s31, -14
    v_lshrrev_b32 v2, 6, v0
    v_mov_b32 v3, 1
    v_readfirstlane_b32 s22, v2
    s_waitcnt lgkmcnt(0)
    s_mov_b32 s16, s6
    s_and_b32 s17, s7, 0xffff
    s_mov_b32 s18, 0x138800
    s_mov_b32 s19, 0x20000
    v_cmp_gt_u32 vcc, 625, v0
    s_mov_b64 exec, vcc
    s_add_u32 s33, s3, 10000
    buffer_load_dwordx4 v[8:11], v1, s[16:19], s3 offen
    buffer_load_dwordx4 v[12:15], v1, s[16:19], s33 offen
    s_mov_b32 s12, s4
    s_and_b32 s13, s5, 0xffff
    s_mov_b32 s14, 0x138800
    s_mov_b32 s15, 0x20000
    buffer_load_dwordx4 v[16:19], v1, s[12:15], s3 offen
    buffer_load_dwordx4 v[20:23], v1, s[12:15], s33 offen
    s_mov_b32 s24, s8
    s_and_b32 s25, s9, 0xffff
    s_mov_b32 s26, 0x200000
    s_mov_b32 s27, 0x20000
    v_lshlrev_b32 v64, 21, v0
    s_barrier
    s_waitcnt vmcnt(2)
    v_mul_u32_u24 v24, s20, v8
    v_mul_u32_u24 v25, s20, v9
    v_mul_u32_u24 v26, s20, v10
    v_mul_u32_u24 v27, s20, v11
    v_mul_u32_u24 v28, s20, v12
    v_mul_u32_u24 v29, s20, v13
    v_mul_u32_u24 v30, s20, v14
    v_mul_u32_u24 v31, s20, v15
    v_lshrrev_b32 v24, 23, v24
    v_lshrrev_b32 v25, 23, v25
    v_lshrrev_b32 v26, 23, v26
    v_lshrrev_b32 v27, 23, v27
    v_lshrrev_b32 v28, 23, v28
    v_lshrrev_b32 v29, 23, v29
    v_lshrrev_b32 v30, 23, v30
    v_lshrrev_b32 v31, 23, v31
    v_mad_u32_u24 v48, v24, s21, 15
    v_mad_u32_u24 v49, v25, s21, 15
    v_mad_u32_u24 v50, v26, s21, 15
    v_mad_u32_u24 v51, v27, s21, 15
    v_mad_u32_u24 v52, v28, s21, 15
    v_mad_u32_u24 v53, v29, s21, 15
    v_mad_u32_u24 v54, v30, s21, 15
    v_mad_u32_u24 v55, v31, s21, 15
    v_lshrrev_b32 v48, 4, v48
    v_lshrrev_b32 v49, 4, v49
    v_lshrrev_b32 v50, 4, v50
    v_lshrrev_b32 v51, 4, v51
    v_lshrrev_b32 v52, 4, v52
    v_lshrrev_b32 v53, 4, v53
    v_lshrrev_b32 v54, 4, v54
    v_lshrrev_b32 v55, 4, v55
    v_sub_u32 v48, v8, v48
    v_sub_u32 v49, v9, v49
    v_sub_u32 v50, v10, v50
    v_sub_u32 v51, v11, v51
    v_sub_u32 v52, v12, v52
    v_sub_u32 v53, v13, v53
    v_sub_u32 v54, v14, v54
    v_sub_u32 v55, v15, v55
    v_add_u32 v56, 48, v48
    v_add_u32 v57, 48, v49
    v_add_u32 v58, 48, v50
    v_add_u32 v59, 48, v51
    v_add_u32 v60, 48, v52
    v_add_u32 v61, 48, v53
    v_add_u32 v62, 48, v54
    v_add_u32 v63, 48, v55
    v_add_u32 v32, 34, v48
    v_add_u32 v33, 34, v49
    v_add_u32 v34, 34, v50
    v_add_u32 v35, 34, v51
    v_add_u32 v36, 34, v52
    v_add_u32 v37, 34, v53
    v_add_u32 v38, 34, v54
    v_add_u32 v39, 34, v55
    v_lshrrev_b32 v56, 6, v56
    v_lshrrev_b32 v57, 6, v57
    v_lshrrev_b32 v58, 6, v58
    v_lshrrev_b32 v59, 6, v59
    v_lshrrev_b32 v60, 6, v60
    v_lshrrev_b32 v61, 6, v61
    v_lshrrev_b32 v62, 6, v62
    v_lshrrev_b32 v63, 6, v63
    v_lshrrev_b32 v32, 6, v32
    v_lshrrev_b32 v33, 6, v33
    v_lshrrev_b32 v34, 6, v34
    v_lshrrev_b32 v35, 6, v35
    v_lshrrev_b32 v36, 6, v36
    v_lshrrev_b32 v37, 6, v37
    v_lshrrev_b32 v38, 6, v38
    v_lshrrev_b32 v39, 6, v39
    v_mad_i32_i24 v48, v56, s28, v48
    v_mad_i32_i24 v49, v57, s28, v49
    v_mad_i32_i24 v50, v58, s28, v50
    v_mad_i32_i24 v51, v59, s28, v51
    v_mad_i32_i24 v52, v60, s28, v52
    v_mad_i32_i24 v53, v61, s28, v53
    v_mad_i32_i24 v54, v62, s28, v54
    v_mad_i32_i24 v55, v63, s28, v55
    v_mad_i32_i24 v48, v32, s31, v48
    v_mad_i32_i24 v49, v33, s31, v49
    v_mad_i32_i24 v50, v34, s31, v50
    v_mad_i32_i24 v51, v35, s31, v51
    v_mad_i32_i24 v52, v36, s31, v52
    v_mad_i32_i24 v53, v37, s31, v53
    v_mad_i32_i24 v54, v38, s31, v54
    v_mad_i32_i24 v55, v39, s31, v55
    v_add_u32 v56, v56, v32
    v_add_u32 v57, v57, v33
    v_add_u32 v58, v58, v34
    v_add_u32 v59, v59, v35
    v_add_u32 v60, v60, v36
    v_add_u32 v61, v61, v37
    v_add_u32 v62, v62, v38
    v_add_u32 v63, v63, v39
    v_lshl_add_u32 v24, v56, 8, v24
    v_lshl_add_u32 v25, v57, 8, v25
    v_lshl_add_u32 v26, v58, 8, v26
    v_lshl_add_u32 v27, v59, 8, v27
    v_lshl_add_u32 v28, v60, 8, v28
    v_lshl_add_u32 v29, v61, 8, v29
    v_lshl_add_u32 v30, v62, 8, v30
    v_lshl_add_u32 v31, v63, 8, v31
    s_waitcnt vmcnt(0)
    s_movk_i32 s29, 6554
    v_mul_u32_u24 v56, s29, v16
    v_mul_u32_u24 v57, s29, v17
    v_mul_u32_u24 v58, s29, v18
    v_mul_u32_u24 v59, s29, v19
    v_mul_u32_u24 v60, s29, v20
    v_mul_u32_u24 v61, s29, v21
    v_mul_u32_u24 v62, s29, v22
    v_mul_u32_u24 v63, s29, v23
    v_lshrrev_b32 v56, 24, v56
    v_lshrrev_b32 v57, 24, v57
    v_lshrrev_b32 v58, 24, v58
    v_lshrrev_b32 v59, 24, v59
    v_lshrrev_b32 v60, 24, v60
    v_lshrrev_b32 v61, 24, v61
    v_lshrrev_b32 v62, 24, v62
    v_lshrrev_b32 v63, 24, v63
    v_lshl_add_u32 v32, v24, 2, v56
    v_lshl_add_u32 v33, v25, 2, v57
    v_lshl_add_u32 v34, v26, 2, v58
    v_lshl_add_u32 v35, v27, 2, v59
    v_lshl_add_u32 v36, v28, 2, v60
    v_lshl_add_u32 v37, v29, 2, v61
    v_lshl_add_u32 v38, v30, 2, v62
    v_lshl_add_u32 v39, v31, 2, v63
    v_lshlrev_b32 v32, 2, v32
    v_lshlrev_b32 v33, 2, v33
    v_lshlrev_b32 v34, 2, v34
    v_lshlrev_b32 v35, 2, v35
    v_lshlrev_b32 v36, 2, v36
    v_lshlrev_b32 v37, 2, v37
    v_lshlrev_b32 v38, 2, v38
    v_lshlrev_b32 v39, 2, v39
    ds_add_rtn_u32 v40, v32, v3
    ds_add_rtn_u32 v41, v33, v3
    ds_add_rtn_u32 v42, v34, v3
    ds_add_rtn_u32 v43, v35, v3
    ds_add_rtn_u32 v44, v36, v3
    ds_add_rtn_u32 v45, v37, v3
    ds_add_rtn_u32 v46, v38, v3
    ds_add_rtn_u32 v47, v39, v3
    v_lshl_or_b32 v48, v48, 14, v16
    v_lshl_or_b32 v49, v49, 14, v17
    v_lshl_or_b32 v50, v50, 14, v18
    v_lshl_or_b32 v51, v51, 14, v19
    v_lshl_or_b32 v52, v52, 14, v20
    v_lshl_or_b32 v53, v53, 14, v21
    v_lshl_or_b32 v54, v54, 14, v22
    v_lshl_or_b32 v55, v55, 14, v23
    s_mov_b32 s30, 0x0
    v_add3_u32 v48, v48, v64, s30
    s_mov_b32 s30, 0x80000
    v_add3_u32 v49, v49, v64, s30
    s_mov_b32 s30, 0x100000
    v_add3_u32 v50, v50, v64, s30
    s_mov_b32 s30, 0x180000
    v_add3_u32 v51, v51, v64, s30
    s_mov_b32 s30, 0x4e200000
    v_add3_u32 v52, v52, v64, s30
    s_mov_b32 s30, 0x4e280000
    v_add3_u32 v53, v53, v64, s30
    s_mov_b32 s30, 0x4e300000
    v_add3_u32 v54, v54, v64, s30
    s_mov_b32 s30, 0x4e380000
    v_add3_u32 v55, v55, v64, s30
    s_waitcnt lgkmcnt(0)
    s_barrier
    s_cmp_ge_u32 s22, 6
    s_cbranch_scc1 P_scan1_done
    v_lshlrev_b32 v2, 5, v0
    ds_read_b128 v[68:71], v2 offset:0
    ds_read_b128 v[72:75], v2 offset:16
    s_waitcnt lgkmcnt(0)
    v_mov_b32 v76, 0
    v_mov_b32 v77, v68
    v_add_u32 v78, v77, v69
    v_add_u32 v79, v78, v70
    v_add_u32 v80, v79, v71
    v_add_u32 v81, v80, v72
    v_add_u32 v82, v81, v73
    v_add_u32 v83, v82, v74
    v_add_u32 v84, v83, v75
    v_mov_b32 v85, v84
    s_nop 1
    v_add_u32_dpp v85, v85, v85 row_shr:1 row_mask:0xf bank_mask:0xf bound_ctrl:1
    s_nop 1
    v_add_u32_dpp v85, v85, v85 row_shr:2 row_mask:0xf bank_mask:0xf bound_ctrl:1
    s_nop 1
    v_add_u32_dpp v85, v85, v85 row_shr:4 row_mask:0xf bank_mask:0xf bound_ctrl:1
    s_nop 1
    v_add_u32_dpp v85, v85, v85 row_shr:8 row_mask:0xf bank_mask:0xf bound_ctrl:1
    s_nop 1
    v_add_u32_dpp v85, v85, v85 row_bcast:15 row_mask:0xa bank_mask:0xf
    s_nop 1
    v_add_u32_dpp v85, v85, v85 row_bcast:31 row_mask:0xc bank_mask:0xf
    s_nop 1
    v_readlane_b32 s23, v85, 63
    v_sub_u32 v85, v85, v84
    s_lshl_b32 s30, s22, 2
    v_mov_b32 v87, s30
    v_mov_b32 v86, s23
    ds_write_b32 v87, v86 offset:24576
    s_waitcnt lgkmcnt(0)
P_scan1_done:
    s_barrier
    s_cmp_ge_u32 s22, 6
    s_cbranch_scc1 P_noscan
    v_mov_b32 v87, 0
    ds_read_b128 v[88:91], v87 offset:24576
    ds_read_b64 v[92:93], v87 offset:24592
    s_waitcnt lgkmcnt(0)
    s_mov_b32 s30, 0
    v_readfirstlane_b32 s23, v88
    s_cmp_gt_u32 s22, 0
    s_nop 1
    s_cselect_b32 s23, s23, 0
    s_add_u32 s30, s30, s23
    v_readfirstlane_b32 s23, v89
    s_cmp_gt_u32 s22, 1
    s_nop 1
    s_cselect_b32 s23, s23, 0
    s_add_u32 s30, s30, s23
    v_readfirstlane_b32 s23, v90
    s_cmp_gt_u32 s22, 2
    s_nop 1
    s_cselect_b32 s23, s23, 0
    s_add_u32 s30, s30, s23
    v_readfirstlane_b32 s23, v91
    s_cmp_gt_u32 s22, 3
    s_nop 1
    s_cselect_b32 s23, s23, 0
    s_add_u32 s30, s30, s23
    v_readfirstlane_b32 s23, v92
    s_cmp_gt_u32 s22, 4
    s_nop 1
    s_cselect_b32 s23, s23, 0
    s_add_u32 s30, s30, s23
    v_add_u32 v85, s30, v85
    v_add_u32 v76, v76, v85
    v_add_u32 v77, v77, v85
    v_add_u32 v78, v78, v85
    v_add_u32 v79, v79, v85
    v_add_u32 v80, v80, v85
    v_add_u32 v81, v81, v85
    v_add_u32 v82, v82, v85
    v_add_u32 v83, v83, v85
    ds_write_b128 v2, v[76:79] offset:12288
    ds_write_b128 v2, v[80:83] offset:12304
    v_add3_u32 v86, v68, v69, v70
    v_add_u32 v86, v86, v71
    v_lshl_or_b32 v88, v86, 16, v76
    v_min_u32 v68, 0xff, v68
    v_min_u32 v69, 0xff, v69
    v_min_u32 v70, 0xff, v70
    v_lshl_or_b32 v89, v69, 8, v68
    v_lshl_or_b32 v89, v70, 16, v89
    v_add3_u32 v86, v72, v73, v74
    v_add_u32 v86, v86, v75
    v_lshl_or_b32 v90, v86, 16, v80
    v_min_u32 v72, 0xff, v72
    v_min_u32 v73, 0xff, v73
    v_min_u32 v74, 0xff, v74
    v_lshl_or_b32 v91, v73, 8, v72
    v_lshl_or_b32 v91, v74, 16, v91
    s_mul_i32 s23, s2, 6144
    v_lshlrev_b32 v86, 4, v0
    buffer_store_dwordx4 v[88:91], v86, s[24:27], s23 offen offset:0 sc0 sc1
    s_waitcnt lgkmcnt(0)
P_noscan:
    s_barrier
    ds_read_b32 v56, v32 offset:12288
    ds_read_b32 v57, v33 offset:12288
    ds_read_b32 v58, v34 offset:12288
    ds_read_b32 v59, v35 offset:12288
    ds_read_b32 v60, v36 offset:12288
    ds_read_b32 v61, v37 offset:12288
    ds_read_b32 v62, v38 offset:12288
    ds_read_b32 v63, v39 offset:12288
    s_waitcnt lgkmcnt(0)
    v_add_lshl_u32 v56, v56, v40, 2
    v_add_lshl_u32 v57, v57, v41, 2
    v_add_lshl_u32 v58, v58, v42, 2
    v_add_lshl_u32 v59, v59, v43, 2
    v_add_lshl_u32 v60, v60, v44, 2
    v_add_lshl_u32 v61, v61, v45, 2
    v_add_lshl_u32 v62, v62, v46, 2
    v_add_lshl_u32 v63, v63, v47, 2
    ds_write_b32 v56, v48 offset:24640
    ds_write_b32 v57, v49 offset:24640
    ds_write_b32 v58, v50 offset:24640
    ds_write_b32 v59, v51 offset:24640
    ds_write_b32 v60, v52 offset:24640
    ds_write_b32 v61, v53 offset:24640
    ds_write_b32 v62, v54 offset:24640
    ds_write_b32 v63, v55 offset:24640
    s_waitcnt lgkmcnt(0)
    s_barrier
    ds_read_b128 v[4:7], v1 offset:24640
    ds_read_b128 v[8:11], v1 offset:34640
    s_add_u32 s3, s3, 524288
    s_add_u32 s33, s3, 10000
    s_waitcnt lgkmcnt(1)
    buffer_store_dwordx4 v[4:7], v1, s[24:27], s3 offen sc0 sc1
    s_waitcnt lgkmcnt(0)
    buffer_store_dwordx4 v[8:11], v1, s[24:27], s33 offen sc0 sc1
    s_endpgm
P_gemm:
    s_load_dwordx2 s[4:5], s[0:1], 0
    s_load_dwordx4 s[8:11], s[0:1], 32
    s_load_dwordx2 s[34:35], s[0:1], 48
    s_load_dwordx2 s[6:7], s[0:1], 72
    v_lshrrev_b32 v2, 6, v0
    v_and_b32 v1, 63, v0
    v_readfirstlane_b32 s22, v2
    s_sub_u32 s3, s2, 64
    s_cmp_ge_u32 s3, 79
    s_cselect_b32 s36, 1, 0
    s_cselect_b32 s37, 79, 0
    s_sub_u32 s3, s3, s37
    s_cmp_ge_u32 s22, 8
    s_cbranch_scc1 P_end
    s_lshr_b32 s23, s22, 2
    s_and_b32 s28, s22, 3
    s_lshl_b32 s3, s3, 2
    s_add_u32 s3, s3, s23
    s_lshl_b32 s29, s3, 5
    v_lshrrev_b32 v3, 4, v1
    v_and_b32 v4, 15, v1
    v_lshlrev_b32 v5, 2, v3
    v_xor_b32 v5, v5, v4
    v_lshlrev_b32 v5, 4, v5
    v_lshl_add_u32 v5, v3, 8, v5
    v_xor_b32 v4, v4, v3
    v_lshlrev_b32 v7, 4, v4
    v_mov_b32 v9, v7
    s_waitcnt lgkmcnt(0)
    s_cmp_eq_u32 s36, 0
    s_cselect_b32 s30, 32768, 0
    s_cselect_b32 s44, s10, s8
    s_cselect_b32 s45, s11, s9
    s_add_u32 s16, s34, s30
    s_addc_u32 s17, s35, 0
    s_and_b32 s17, s17, 0xffff
    s_mov_b32 s18, 32768
    s_mov_b32 s19, 0x20000
    s_and_b32 s45, s45, 0xffff
    s_mov_b32 s46, 32768
    s_mov_b32 s47, 0x20000
    s_mov_b32 s12, s4
    s_and_b32 s13, s5, 0xffff
    s_or_b32 s13, s13, 0x1000000
    s_mov_b32 s14, 0x2710
    s_mov_b32 s15, 0x20000
    s_lshl_b32 s33, s22, 12
    s_lshl_b32 s30, s28, 3
    s_add_u32 s30, s30, s29
    s_mul_i32 s31, s23, 8704
    s_mul_i32 s37, s28, 2176
    s_add_u32 s31, s31, s37
    s_add_u32 m0, s33, 0
    s_nop 0
    buffer_load_dwordx4 v5, s[16:19], s33 offen offset:0 lds
    buffer_load_dwordx4 v5, s[16:19], s33 offen offset:1024 lds
    buffer_load_dwordx4 v5, s[16:19], s33 offen offset:2048 lds
    buffer_load_dwordx4 v5, s[16:19], s33 offen offset:3072 lds
    v_add_u32 v6, s30, v3
    v_add_u32 v8, 4, v6
    s_add_u32 m0, s31, 65536
    s_add_u32 s30, s30, 64
    buffer_load_dwordx4 v[6:7], s[12:15], 0 idxen offen lds
    s_add_u32 m0, s31, 66624
    s_nop 0
    buffer_load_dwordx4 v[8:9], s[12:15], 0 idxen offen lds
    s_add_u32 m0, s33, 32768
    s_nop 0
    buffer_load_dwordx4 v5, s[44:47], s33 offen offset:0 lds
    buffer_load_dwordx4 v5, s[44:47], s33 offen offset:1024 lds
    buffer_load_dwordx4 v5, s[44:47], s33 offen offset:2048 lds
    buffer_load_dwordx4 v5, s[44:47], s33 offen offset:3072 lds
    v_add_u32 v6, s30, v3
    v_add_u32 v8, 4, v6
    s_add_u32 m0, s31, 82944
    s_add_u32 s30, s30, 64
    buffer_load_dwordx4 v[6:7], s[12:15], 0 idxen offen lds
    s_add_u32 m0, s31, 84032
    s_nop 0
    buffer_load_dwordx4 v[8:9], s[12:15], 0 idxen offen lds
    v_and_b32 v10, 31, v1
    v_lshrrev_b32 v11, 5, v1
    v_lshrrev_b32 v15, 2, v10
    v_mul_u32_u24 v15, 1088, v15
    v_and_b32 v16, 3, v10
    v_lshl_add_u32 v15, v16, 8, v15
    v_xor_b32 v17, v11, v16
    v_lshl_add_u32 v12, v17, 4, v15
    v_xor_b32 v17, 2, v17
    v_lshl_add_u32 v13, v17, 4, v15
    s_mul_i32 s30, s23, 8704
    s_add_u32 s30, s30, 65536
    v_add_u32 v12, s30, v12
    v_add_u32 v13, s30, v13
    v_lshrrev_b32 v15, 2, v1
    v_and_b32 v15, 3, v15
    s_lshl_b32 s30, s28, 2
    v_lshlrev_b32 v16, 2, v15
    v_xor_b32 v16, s30, v16
    v_lshrrev_b32 v17, 4, v1
    v_and_b32 v17, 1, v17
    v_lshl_add_u32 v16, v17, 1, v16
    v_lshrrev_b32 v17, 1, v1
    v_and_b32 v17, 1, v17
    v_add_u32 v16, v16, v17
    v_lshlrev_b32 v16, 4, v16
    v_and_b32 v17, 1, v1
    v_lshl_add_u32 v16, v17, 3, v16
    v_lshl_add_u32 v15, v11, 3, v15
    v_lshl_add_u32 v14, v15, 8, v16
    s_add_u32 s24, s6, 0x200000
    s_addc_u32 s25, s7, 0
    s_and_b32 s25, s25, 0xffff
    s_mov_b32 s26, 0x4e2000
    s_mov_b32 s27, 0x20000
    s_cmp_eq_u32 s36, 0
    s_cbranch_scc1 P_g_bvsrd
    s_add_u32 s24, s6, 0x700000
    s_addc_u32 s25, s7, 0
    s_and_b32 s25, s25, 0xffff
    s_mov_b32 s26, 0x271000
    s_mov_b32 s27, 0x20000
    s_add_u32 s40, s6, 0x980000
    s_addc_u32 s41, s7, 0
    s_and_b32 s41, s41, 0xffff
    s_mov_b32 s42, 0x271000
    s_mov_b32 s43, 0x20000
P_g_bvsrd:
    s_lshl_b32 s31, s22, 12
    s_add_u32 s31, s31, 100352
    v_and_b32 v15, 7, v10
    v_lshlrev_b32 v16, 1, v11
    v_xor_b32 v16, v16, v15
    v_lshlrev_b32 v16, 4, v16
    v_lshl_add_u32 v16, v10, 7, v16
    v_add_u32 v16, s31, v16
    v_lshrrev_b32 v20, 3, v1
    v_and_b32 v21, 7, v1
    v_xor_b32 v22, v21, v20
    v_lshlrev_b32 v22, 4, v22
    v_lshl_add_u32 v22, v20, 7, v22
    v_add_u32 v22, s31, v22
    v_add_u32 v20, s29, v20
    v_lshlrev_b32 v20, 9, v20
    v_lshl_add_u32 v20, v21, 4, v20
    s_lshl_b32 s30, s28, 7
    v_add_u32 v20, s30, v20
    v_lshrrev_b32 v23, 2, v10
    v_and_b32 v23, 3, v23
    v_lshlrev_b32 v23, 4, v23
    v_lshl_add_u32 v23, v10, 6, v23
    v_lshl_add_u32 v23, v11, 3, v23
    v_add_u32 v23, s31, v23
    v_lshrrev_b32 v24, 4, v1
    v_and_b32 v24, 3, v24
    v_and_b32 v25, 3, v1
    v_xor_b32 v24, v24, v25
    v_lshlrev_b32 v24, 4, v24
    v_lshrrev_b32 v26, 2, v1
    v_lshl_add_u32 v24, v26, 6, v24
    v_add_u32 v24, s31, v24
    v_add_u32 v26, s29, v26
    v_lshlrev_b32 v26, 8, v26
    v_lshl_add_u32 v26, v25, 4, v26
    s_lshl_b32 s30, s28, 6
    v_add_u32 v26, s30, v26
    s_waitcnt vmcnt(6)
    s_barrier
    ds_read_b64_tr_b16 v[32:33], v14 offset:0
    ds_read_b64_tr_b16 v[34:35], v14 offset:1024
    ds_read_b64_tr_b16 v[36:37], v14 offset:4096
    ds_read_b64_tr_b16 v[38:39], v14 offset:5120
    ds_read_b64_tr_b16 v[40:41], v14 offset:8192
    ds_read_b64_tr_b16 v[42:43], v14 offset:9216
    ds_read_b64_tr_b16 v[44:45], v14 offset:12288
    ds_read_b64_tr_b16 v[46:47], v14 offset:13312
    ds_read_b64_tr_b16 v[48:49], v14 offset:16384
    ds_read_b64_tr_b16 v[50:51], v14 offset:17408
    ds_read_b64_tr_b16 v[52:53], v14 offset:20480
    ds_read_b64_tr_b16 v[54:55], v14 offset:21504
    s_waitcnt lgkmcnt(4)
    ds_read_b64_tr_b16 v[56:57], v14 offset:24576
    ds_read_b64_tr_b16 v[58:59], v14 offset:25600
    ds_read_b64_tr_b16 v[60:61], v14 offset:28672
    ds_read_b64_tr_b16 v[62:63], v14 offset:29696
    s_waitcnt lgkmcnt(4)
    ds_read_b128 v[96:99], v12 offset:0
    ds_read_b128 v[100:103], v13 offset:0
    ds_read_b128 v[104:107], v12 offset:64
    ds_read_b128 v[108:111], v13 offset:64
    ds_read_b128 v[112:115], v12 offset:128
    ds_read_b128 v[116:119], v13 offset:128
    ds_read_b128 v[120:123], v12 offset:192
    ds_read_b128 v[124:127], v13 offset:192
    s_mov_b32 s30, 0xbfb8aa3b
    s_waitcnt lgkmcnt(6)
    v_mfma_f32_32x32x16_bf16 v[128:143], v[32:35], v[96:99], 0
    v_mfma_f32_32x32x16_bf16 v[128:143], v[36:39], v[100:103], v[128:143]
    s_waitcnt lgkmcnt(4)
    v_mfma_f32_32x32x16_bf16 v[128:143], v[40:43], v[104:107], v[128:143]
    v_mfma_f32_32x32x16_bf16 v[128:143], v[44:47], v[108:111], v[128:143]
    s_waitcnt lgkmcnt(2)
    v_mfma_f32_32x32x16_bf16 v[128:143], v[48:51], v[112:115], v[128:143]
    v_mfma_f32_32x32x16_bf16 v[128:143], v[52:55], v[116:119], v[128:143]
    s_waitcnt lgkmcnt(0)
    v_mfma_f32_32x32x16_bf16 v[128:143], v[56:59], v[120:123], v[128:143]
    v_mfma_f32_32x32x16_bf16 v[128:143], v[60:63], v[124:127], v[128:143]
    s_waitcnt vmcnt(0)
    s_barrier
    ds_read_b64_tr_b16 v[64:65], v14 offset:32768
    ds_read_b64_tr_b16 v[66:67], v14 offset:33792
    ds_read_b64_tr_b16 v[68:69], v14 offset:36864
    ds_read_b64_tr_b16 v[70:71], v14 offset:37888
    ds_read_b64_tr_b16 v[72:73], v14 offset:40960
    ds_read_b64_tr_b16 v[74:75], v14 offset:41984
    ds_read_b64_tr_b16 v[76:77], v14 offset:45056
    ds_read_b64_tr_b16 v[78:79], v14 offset:46080
    ds_read_b64_tr_b16 v[80:81], v14 offset:49152
    ds_read_b64_tr_b16 v[82:83], v14 offset:50176
    ds_read_b64_tr_b16 v[84:85], v14 offset:53248
    ds_read_b64_tr_b16 v[86:87], v14 offset:54272
    s_waitcnt lgkmcnt(8)
    ds_read_b64_tr_b16 v[88:89], v14 offset:57344
    ds_read_b64_tr_b16 v[90:91], v14 offset:58368
    ds_read_b64_tr_b16 v[92:93], v14 offset:61440
    ds_read_b64_tr_b16 v[94:95], v14 offset:62464
    s_waitcnt lgkmcnt(0)
    v_mfma_f32_32x32x16_bf16 v[144:159], v[64:67], v[96:99], 0
    v_mfma_f32_32x32x16_bf16 v[144:159], v[68:71], v[100:103], v[144:159]
    v_mfma_f32_32x32x16_bf16 v[144:159], v[72:75], v[104:107], v[144:159]
    v_mfma_f32_32x32x16_bf16 v[144:159], v[76:79], v[108:111], v[144:159]
    v_mfma_f32_32x32x16_bf16 v[144:159], v[80:83], v[112:115], v[144:159]
    v_mfma_f32_32x32x16_bf16 v[144:159], v[84:87], v[116:119], v[144:159]
    v_mfma_f32_32x32x16_bf16 v[144:159], v[88:91], v[120:123], v[144:159]
    v_mfma_f32_32x32x16_bf16 v[144:159], v[92:95], v[124:127], v[144:159]
    s_nop 3
    v_mul_f32 v128, s30, v128
    v_mul_f32 v129, s30, v129
    v_mul_f32 v130, s30, v130
    v_mul_f32 v131, s30, v131
    v_mul_f32 v132, s30, v132
    v_mul_f32 v133, s30, v133
    v_mul_f32 v134, s30, v134
    v_mul_f32 v135, s30, v135
    v_mul_f32 v136, s30, v136
    v_mul_f32 v137, s30, v137
    v_mul_f32 v138, s30, v138
    v_mul_f32 v139, s30, v139
    v_mul_f32 v140, s30, v140
    v_mul_f32 v141, s30, v141
    v_mul_f32 v142, s30, v142
    v_mul_f32 v143, s30, v143
    v_cvt_pk_bf16_f32 v128, v128, v129
    v_cvt_pk_bf16_f32 v129, v130, v131
    v_cvt_pk_bf16_f32 v130, v132, v133
    v_cvt_pk_bf16_f32 v131, v134, v135
    v_cvt_pk_bf16_f32 v132, v136, v137
    v_cvt_pk_bf16_f32 v133, v138, v139
    v_cvt_pk_bf16_f32 v134, v140, v141
    v_cvt_pk_bf16_f32 v135, v142, v143
    v_cvt_pk_bf16_f32 v136, v144, v145
    v_cvt_pk_bf16_f32 v137, v146, v147
    v_cvt_pk_bf16_f32 v138, v148, v149
    v_cvt_pk_bf16_f32 v139, v150, v151
    v_cvt_pk_bf16_f32 v140, v152, v153
    v_cvt_pk_bf16_f32 v141, v154, v155
    v_cvt_pk_bf16_f32 v142, v156, v157
    v_cvt_pk_bf16_f32 v143, v158, v159
    s_cmp_eq_u32 s36, 0
    s_cbranch_scc0 P_g_au0
    ds_write_b128 v16, v[128:131]
    v_xor_b32 v17, 16, v16
    ds_write_b128 v17, v[132:135]
    v_xor_b32 v18, 64, v16
    ds_write_b128 v18, v[136:139]
    v_xor_b32 v19, 64, v17
    ds_write_b128 v19, v[140:143]
    ds_read_b128 v[144:147], v22 offset:0
    ds_read_b128 v[148:151], v22 offset:1024
    ds_read_b128 v[152:155], v22 offset:2048
    ds_read_b128 v[156:159], v22 offset:3072
    s_waitcnt lgkmcnt(4)
    ds_read_b128 v[96:99], v12 offset:17408
    ds_read_b128 v[100:103], v13 offset:17408
    ds_read_b128 v[104:107], v12 offset:17472
    ds_read_b128 v[108:111], v13 offset:17472
    ds_read_b128 v[112:115], v12 offset:17536
    ds_read_b128 v[116:119], v13 offset:17536
    ds_read_b128 v[120:123], v12 offset:17600
    ds_read_b128 v[124:127], v13 offset:17600
    s_mov_b32 s33, 0
    s_waitcnt lgkmcnt(11)
    buffer_store_dwordx4 v[144:147], v20, s[24:27], s33 offen sc0 sc1
    s_add_u32 s33, s33, 4096
    s_waitcnt lgkmcnt(10)
    buffer_store_dwordx4 v[148:151], v20, s[24:27], s33 offen sc0 sc1
    s_add_u32 s33, s33, 4096
    s_waitcnt lgkmcnt(9)
    buffer_store_dwordx4 v[152:155], v20, s[24:27], s33 offen sc0 sc1
    s_add_u32 s33, s33, 4096
    s_waitcnt lgkmcnt(8)
    buffer_store_dwordx4 v[156:159], v20, s[24:27], s33 offen sc0 sc1
    s_branch P_g_done0
P_g_au0:
    ds_write_b64 v23, v[128:129]
    ds_write_b64 v23, v[136:137] offset:2048
    v_xor_b32 v17, 16, v23
    ds_write_b64 v17, v[130:131]
    ds_write_b64 v17, v[138:139] offset:2048
    v_xor_b32 v17, 32, v23
    ds_write_b64 v17, v[132:133]
    ds_write_b64 v17, v[140:141] offset:2048
    v_xor_b32 v17, 48, v23
    ds_write_b64 v17, v[134:135]
    ds_write_b64 v17, v[142:143] offset:2048
    ds_read_b128 v[144:147], v24 offset:0
    ds_read_b128 v[148:151], v24 offset:1024
    ds_read_b128 v[152:155], v24 offset:2048
    ds_read_b128 v[156:159], v24 offset:3072
    s_waitcnt lgkmcnt(4)
    ds_read_b128 v[96:99], v12 offset:17408
    ds_read_b128 v[100:103], v13 offset:17408
    ds_read_b128 v[104:107], v12 offset:17472
    ds_read_b128 v[108:111], v13 offset:17472
    ds_read_b128 v[112:115], v12 offset:17536
    ds_read_b128 v[116:119], v13 offset:17536
    ds_read_b128 v[120:123], v12 offset:17600
    ds_read_b128 v[124:127], v13 offset:17600
    s_mov_b32 s33, 0
    s_waitcnt lgkmcnt(11)
    buffer_store_dwordx4 v[144:147], v26, s[24:27], s33 offen offset:0 sc0 sc1
    s_add_u32 s33, s33, 4096
    s_waitcnt lgkmcnt(10)
    buffer_store_dwordx4 v[148:151], v26, s[24:27], s33 offen offset:0 sc0 sc1
    s_sub_u32 s33, s33, 4096
    s_waitcnt lgkmcnt(9)
    buffer_store_dwordx4 v[152:155], v26, s[40:43], s33 offen offset:0 sc0 sc1
    s_add_u32 s33, s33, 4096
    s_waitcnt lgkmcnt(8)
    buffer_store_dwordx4 v[156:159], v26, s[40:43], s33 offen offset:0 sc0 sc1
P_g_done0:
    s_waitcnt lgkmcnt(0)
    v_mfma_f32_32x32x16_bf16 v[128:143], v[32:35], v[96:99], 0
    v_mfma_f32_32x32x16_bf16 v[128:143], v[36:39], v[100:103], v[128:143]
    v_mfma_f32_32x32x16_bf16 v[128:143], v[40:43], v[104:107], v[128:143]
    v_mfma_f32_32x32x16_bf16 v[128:143], v[44:47], v[108:111], v[128:143]
    v_mfma_f32_32x32x16_bf16 v[128:143], v[48:51], v[112:115], v[128:143]
    v_mfma_f32_32x32x16_bf16 v[128:143], v[52:55], v[116:119], v[128:143]
    v_mfma_f32_32x32x16_bf16 v[128:143], v[56:59], v[120:123], v[128:143]
    v_mfma_f32_32x32x16_bf16 v[128:143], v[60:63], v[124:127], v[128:143]
    v_mfma_f32_32x32x16_bf16 v[144:159], v[64:67], v[96:99], 0
    v_mfma_f32_32x32x16_bf16 v[144:159], v[68:71], v[100:103], v[144:159]
    v_mfma_f32_32x32x16_bf16 v[144:159], v[72:75], v[104:107], v[144:159]
    v_mfma_f32_32x32x16_bf16 v[144:159], v[76:79], v[108:111], v[144:159]
    v_mfma_f32_32x32x16_bf16 v[144:159], v[80:83], v[112:115], v[144:159]
    v_mfma_f32_32x32x16_bf16 v[144:159], v[84:87], v[116:119], v[144:159]
    v_mfma_f32_32x32x16_bf16 v[144:159], v[88:91], v[120:123], v[144:159]
    v_mfma_f32_32x32x16_bf16 v[144:159], v[92:95], v[124:127], v[144:159]
    s_nop 3
    v_mul_f32 v128, s30, v128
    v_mul_f32 v129, s30, v129
    v_mul_f32 v130, s30, v130
    v_mul_f32 v131, s30, v131
    v_mul_f32 v132, s30, v132
    v_mul_f32 v133, s30, v133
    v_mul_f32 v134, s30, v134
    v_mul_f32 v135, s30, v135
    v_mul_f32 v136, s30, v136
    v_mul_f32 v137, s30, v137
    v_mul_f32 v138, s30, v138
    v_mul_f32 v139, s30, v139
    v_mul_f32 v140, s30, v140
    v_mul_f32 v141, s30, v141
    v_mul_f32 v142, s30, v142
    v_mul_f32 v143, s30, v143
    v_cvt_pk_bf16_f32 v128, v128, v129
    v_cvt_pk_bf16_f32 v129, v130, v131
    v_cvt_pk_bf16_f32 v130, v132, v133
    v_cvt_pk_bf16_f32 v131, v134, v135
    v_cvt_pk_bf16_f32 v132, v136, v137
    v_cvt_pk_bf16_f32 v133, v138, v139
    v_cvt_pk_bf16_f32 v134, v140, v141
    v_cvt_pk_bf16_f32 v135, v142, v143
    v_cvt_pk_bf16_f32 v136, v144, v145
    v_cvt_pk_bf16_f32 v137, v146, v147
    v_cvt_pk_bf16_f32 v138, v148, v149
    v_cvt_pk_bf16_f32 v139, v150, v151
    v_cvt_pk_bf16_f32 v140, v152, v153
    v_cvt_pk_bf16_f32 v141, v154, v155
    v_cvt_pk_bf16_f32 v142, v156, v157
    v_cvt_pk_bf16_f32 v143, v158, v159
    s_cmp_eq_u32 s36, 0
    s_cbranch_scc0 P_g_au1
    ds_write_b128 v16, v[128:131]
    v_xor_b32 v17, 16, v16
    ds_write_b128 v17, v[132:135]
    v_xor_b32 v18, 64, v16
    ds_write_b128 v18, v[136:139]
    v_xor_b32 v19, 64, v17
    ds_write_b128 v19, v[140:143]
    ds_read_b128 v[144:147], v22 offset:0
    ds_read_b128 v[148:151], v22 offset:1024
    ds_read_b128 v[152:155], v22 offset:2048
    ds_read_b128 v[156:159], v22 offset:3072
    s_mov_b32 s33, 32768
    s_waitcnt lgkmcnt(3)
    buffer_store_dwordx4 v[144:147], v20, s[24:27], s33 offen sc0 sc1
    s_add_u32 s33, s33, 4096
    s_waitcnt lgkmcnt(2)
    buffer_store_dwordx4 v[148:151], v20, s[24:27], s33 offen sc0 sc1
    s_add_u32 s33, s33, 4096
    s_waitcnt lgkmcnt(1)
    buffer_store_dwordx4 v[152:155], v20, s[24:27], s33 offen sc0 sc1
    s_add_u32 s33, s33, 4096
    s_waitcnt lgkmcnt(0)
    buffer_store_dwordx4 v[156:159], v20, s[24:27], s33 offen sc0 sc1
    s_branch P_g_done1
P_g_au1:
    ds_write_b64 v23, v[128:129]
    ds_write_b64 v23, v[136:137] offset:2048
    v_xor_b32 v17, 16, v23
    ds_write_b64 v17, v[130:131]
    ds_write_b64 v17, v[138:139] offset:2048
    v_xor_b32 v17, 32, v23
    ds_write_b64 v17, v[132:133]
    ds_write_b64 v17, v[140:141] offset:2048
    v_xor_b32 v17, 48, v23
    ds_write_b64 v17, v[134:135]
    ds_write_b64 v17, v[142:143] offset:2048
    ds_read_b128 v[144:147], v24 offset:0
    ds_read_b128 v[148:151], v24 offset:1024
    ds_read_b128 v[152:155], v24 offset:2048
    ds_read_b128 v[156:159], v24 offset:3072
    s_mov_b32 s33, 16384
    s_waitcnt lgkmcnt(3)
    buffer_store_dwordx4 v[144:147], v26, s[24:27], s33 offen offset:0 sc0 sc1
    s_add_u32 s33, s33, 4096
    s_waitcnt lgkmcnt(2)
    buffer_store_dwordx4 v[148:151], v26, s[24:27], s33 offen offset:0 sc0 sc1
    s_sub_u32 s33, s33, 4096
    s_waitcnt lgkmcnt(1)
    buffer_store_dwordx4 v[152:155], v26, s[40:43], s33 offen offset:0 sc0 sc1
    s_add_u32 s33, s33, 4096
    s_waitcnt lgkmcnt(0)
    buffer_store_dwordx4 v[156:159], v26, s[40:43], s33 offen offset:0 sc0 sc1
P_g_done1:
    s_endpgm
P_weights:
    s_load_dwordx2 s[8:9], s[0:1], 48
    s_load_dwordx2 s[10:11], s[0:1], 72
    v_lshrrev_b32 v2, 6, v0
    v_and_b32 v1, 63, v0
    v_readfirstlane_b32 s3, v2
    s_nop 0
    s_cmp_ge_u32 s3, 4
    s_cbranch_scc1 P_end
    s_waitcnt lgkmcnt(0)
    s_mov_b32 s12, s8
    s_and_b32 s13, s9, 0xffff
    s_mov_b32 s14, 0x11000
    s_mov_b32 s15, 0x20000
    s_lshl_b32 s28, s3, 6
    s_add_u32 s28, s28, 65536
    v_lshrrev_b32 v2, 5, v1
    v_lshlrev_b32 v2, 11, v2
    v_and_b32 v3, 31, v1
    v_lshl_add_u32 v2, v3, 1, v2
    buffer_load_ushort v8, v2, s[12:15], s28 offen offset:0
    buffer_load_ushort v9, v2, s[12:15], s28 offen offset:256
    buffer_load_ushort v10, v2, s[12:15], s28 offen offset:512
    buffer_load_ushort v11, v2, s[12:15], s28 offen offset:768
    buffer_load_ushort v12, v2, s[12:15], s28 offen offset:1024
    buffer_load_ushort v13, v2, s[12:15], s28 offen offset:1280
    buffer_load_ushort v14, v2, s[12:15], s28 offen offset:1536
    buffer_load_ushort v15, v2, s[12:15], s28 offen offset:1792
    s_mov_b32 s16, s10
    s_and_b32 s17, s11, 0xffff
    s_mov_b32 s18, 0x200000
    s_mov_b32 s19, 0x20000
    s_lshl_b32 s3, s3, 10
    s_add_u32 s3, s3, 393216
    v_lshlrev_b32 v1, 4, v1
    s_mov_b32 s29, 0xbfb8aa3b
    s_waitcnt vmcnt(0)
    v_lshlrev_b32 v8, 16, v8
    v_lshlrev_b32 v9, 16, v9
    v_lshlrev_b32 v10, 16, v10
    v_lshlrev_b32 v11, 16, v11
    v_lshlrev_b32 v12, 16, v12
    v_lshlrev_b32 v13, 16, v13
    v_lshlrev_b32 v14, 16, v14
    v_lshlrev_b32 v15, 16, v15
    v_mul_f32 v8, s29, v8
    v_mul_f32 v9, s29, v9
    v_mul_f32 v10, s29, v10
    v_mul_f32 v11, s29, v11
    v_mul_f32 v12, s29, v12
    v_mul_f32 v13, s29, v13
    v_mul_f32 v14, s29, v14
    v_mul_f32 v15, s29, v15
    v_cvt_pk_bf16_f32 v16, v8, v9
    v_cvt_pk_bf16_f32 v17, v10, v11
    v_cvt_pk_bf16_f32 v18, v12, v13
    v_cvt_pk_bf16_f32 v19, v14, v15
    buffer_store_dwordx4 v[16:19], v1, s[16:19], s3 offen
P_end:
    s_endpgm
.section .rodata,"a"
.p2align 6
.amdhsa_kernel prep_kernel
  .amdhsa_next_free_vgpr 160
  .amdhsa_next_free_sgpr 48
  .amdhsa_accum_offset 160
  .amdhsa_group_segment_fixed_size 0
  .amdhsa_kernarg_size 80
  .amdhsa_user_sgpr_count 2
  .amdhsa_user_sgpr_kernarg_segment_ptr 1
  .amdhsa_system_sgpr_workgroup_id_x 1
  .amdhsa_float_denorm_mode_32 3
.end_amdhsa_kernel
.text
.globl gather_scatter__edge_featured_mpnn_egc__graph_kernel
.p2align 8
.type gather_scatter__edge_featured_mpnn_egc__graph_kernel,@function
gather_scatter__edge_featured_mpnn_egc__graph_kernel:
    s_cmp_ge_u32 s2, 768
    s_cbranch_scc1 M_end
    s_load_dwordx2 s[6:7], s[0:1], 8
    s_load_dwordx2 s[8:9], s[0:1], 56
    s_load_dwordx2 s[10:11], s[0:1], 72
    s_setprio 3
    v_lshrrev_b32 v32, 6, v0
    v_and_b32 v1, 63, v0
    v_readfirstlane_b32 s32, v32
    v_mul_u32_u24 v33, 6144, v1
    s_lshl_b32 s38, s2, 3
    s_and_b32 s33, s2, 255
    s_lshr_b32 s39, s2, 8
    s_mul_i32 s33, s33, 625
    s_add_u32 s34, s33, 640
    s_add_u32 s33, s33, 15
    s_lshr_b32 s33, s33, 4
    s_lshr_b32 s34, s34, 4
    s_sub_u32 s34, s34, s33
    s_sub_u32 s34, s34, 30
    s_cmp_eq_u32 s39, 1
    s_cselect_b32 s34, 14, s34
    s_cselect_b32 s42, 16, 30
    s_cmp_eq_u32 s39, 0
    s_cselect_b32 s34, 16, s34
    s_cselect_b32 s42, 0, s42
    s_add_u32 s33, s33, s42
    v_and_b32 v2, 31, v1
    v_lshrrev_b32 v3, 5, v1
    s_waitcnt lgkmcnt(0)
    s_mov_b32 s20, s10
    s_and_b32 s21, s11, 0xffff
    s_mov_b32 s22, 0x200000
    s_mov_b32 s23, 0x20000
    s_cmp_lg_u32 s32, 0
    s_cbranch_scc1 M_noT
    buffer_load_dwordx2 v[36:37], v33, s[20:23], s38 offen
M_noT:
    s_add_u32 s24, s10, 0x200000
    s_addc_u32 s25, s11, 0
    s_and_b32 s25, s25, 0xffff
    s_or_b32 s25, s25, 0x2000000
    s_mov_b32 s26, 0x2710
    s_mov_b32 s27, 0x20000
    s_mov_b32 s16, s6
    s_and_b32 s17, s7, 0xffff
    s_or_b32 s17, s17, 0x200000
    s_mov_b32 s18, 0x4e200
    s_mov_b32 s19, 0x20000
    s_mov_b32 s28, s8
    s_and_b32 s29, s9, 0xffff
    s_mov_b32 s30, 0x271000
    s_mov_b32 s31, 0x20000
    s_add_u32 s12, s10, 0x700000
    s_addc_u32 s13, s11, 0
    s_and_b32 s13, s13, 0xffff
    s_or_b32 s13, s13, 0x1000000
    s_mov_b32 s14, 0x2710
    s_mov_b32 s15, 0x20000
    s_add_u32 s44, s10, 0x980000
    s_addc_u32 s45, s11, 0
    s_and_b32 s45, s45, 0xffff
    s_mov_b32 s46, 0x271000
    s_mov_b32 s47, 0x20000
    v_lshrrev_b32 v32, 4, v1
    v_and_b32 v33, 7, v1
    v_xor_b32 v33, v33, v32
    s_lshl_b32 s38, s32, 7
    v_lshl_add_u32 v17, v33, 4, s38
    v_xor_b32 v19, 64, v17
    v_mov_b32 v21, v17
    v_mov_b32 v23, v19
    v_lshrrev_b32 v32, 1, v2
    v_and_b32 v32, 7, v32
    v_xor_b32 v32, v32, v3
    v_lshlrev_b32 v32, 4, v32
    v_lshl_add_u32 v32, v2, 7, v32
    s_lshl_b32 s40, s32, 13
    v_add_u32 v4, s40, v32
    v_xor_b32 v5, 32, v4
    v_xor_b32 v6, 64, v4
    v_xor_b32 v7, 96, v4
    s_lshl_b32 s41, s32, 8
    s_add_u32 s41, s41, 36864
    v_lshlrev_b32 v33, 5, v2
    v_bfe_u32 v32, v2, 3, 1
    v_xor_b32 v32, v32, v3
    v_lshl_add_u32 v32, v32, 4, v33
    v_add_u32 v8, 36864, v32
    v_lshl_add_u32 v32, v3, 4, v33
    v_add_u32 v9, 39936, v32
    v_bfe_u32 v33, v1, 2, 2
    v_lshl_add_u32 v33, v3, 2, v33
    v_and_b32 v32, 3, v1
    v_lshlrev_b32 v32, 3, v32
    v_lshl_add_u32 v32, v33, 5, v32
    v_add_u32 v10, 39936, v32
    s_and_b32 s38, s32, 1
    v_and_b32 v32, 1, v1
    v_xor_b32 v32, s38, v32
    v_lshlrev_b32 v25, 4, v32
    v_and_b32 v32, 7, v1
    s_lshl_b32 s38, s32, 3
    v_add_u32 v32, s38, v32
    v_lshlrev_b32 v33, 5, v32
    v_bfe_u32 v34, v1, 3, 1
    v_mul_i32_i24 v35, -2048, v34
    v_add_u32 v35, 41984, v35
    v_add_u32 v29, v35, v33
    v_mul_i32_i24 v35, 1024, v34
    v_add_u32 v35, 39936, v35
    v_add_u32 v30, v35, v33
    v_mul_i32_i24 v35, 1024, v34
    v_add_u32 v35, 40960, v35
    v_add_u32 v31, v35, v33
    v_sub_u32 v35, 1, v34
    v_mul_u32_u24 v28, 0x3f80, v35
    v_lshlrev_b32 v34, 6, v34
    v_sub_u32 v32, v32, v34
    v_add_u32 v54, 49216, v32
    v_and_b32 v32, 1, v2
    v_lshlrev_b32 v32, 4, v32
    v_mov_b32 v33, 0x3f80
    v_lshlrev_b32 v32, v32, v33
    v_bfe_u32 v33, v2, 1, 1
    v_lshrrev_b32 v34, 2, v2
    v_and_b32 v35, 2, v34
    v_or_b32 v33, v33, v35
    v_and_b32 v34, 1, v34
    v_lshl_add_u32 v33, v34, 2, v33
    v_lshrrev_b32 v34, 4, v2
    v_xor_b32 v34, v34, v3
    v_lshl_add_u32 v33, v34, 3, v33
    v_cmp_eq_u32 vcc, 0, v33
    v_cmp_eq_u32 s[48:49], 1, v33
    v_cmp_eq_u32 s[50:51], 2, v33
    v_cmp_eq_u32 s[54:55], 3, v33
    v_cndmask_b32 v64, 0, v32, vcc
    v_cndmask_b32 v65, 0, v32, s[48:49]
    v_cndmask_b32 v66, 0, v32, s[50:51]
    v_cndmask_b32 v67, 0, v32, s[54:55]
    v_cmp_eq_u32 vcc, 4, v33
    v_cmp_eq_u32 s[48:49], 5, v33
    v_cmp_eq_u32 s[50:51], 6, v33
    v_cmp_eq_u32 s[54:55], 7, v33
    v_cndmask_b32 v68, 0, v32, vcc
    v_cndmask_b32 v69, 0, v32, s[48:49]
    v_cndmask_b32 v70, 0, v32, s[50:51]
    v_cndmask_b32 v71, 0, v32, s[54:55]
    v_mov_b32 v72, 0
    v_mov_b32 v73, 0
    v_mov_b32 v74, 0
    v_mov_b32 v75, 0
    v_mov_b32 v76, 0
    v_mov_b32 v77, 0
    v_mov_b32 v78, 0
    v_mov_b32 v79, 0
    s_cmp_lg_u32 s32, 0
    s_cbranch_scc1 M_scan_done
    v_mul_u32_u24 v35, 5000, v1
    s_waitcnt vmcnt(0)
    v_lshrrev_b32 v33, 16, v36
    v_and_b32 v104, 0xff, v37
    v_bfe_u32 v105, v37, 8, 8
    v_bfe_u32 v106, v37, 16, 8
    v_add3_u32 v32, v104, v105, v106
    v_sub_u32 v107, v33, v32
    v_mov_b32 v108, v104
    v_mov_b32 v109, v105
    v_mov_b32 v110, v106
    v_mov_b32 v111, v107
    v_and_b32 v34, 0xffff, v36
    v_add_u32_dpp v108, v108, v108 row_shr:1 row_mask:0xf bank_mask:0xf bound_ctrl:1
    v_add_u32_dpp v109, v109, v109 row_shr:1 row_mask:0xf bank_mask:0xf bound_ctrl:1
    v_add_u32_dpp v110, v110, v110 row_shr:1 row_mask:0xf bank_mask:0xf bound_ctrl:1
    v_add_u32_dpp v111, v111, v111 row_shr:1 row_mask:0xf bank_mask:0xf bound_ctrl:1
    v_add_u32_dpp v108, v108, v108 row_shr:2 row_mask:0xf bank_mask:0xf bound_ctrl:1
    v_add_u32_dpp v109, v109, v109 row_shr:2 row_mask:0xf bank_mask:0xf bound_ctrl:1
    v_add_u32_dpp v110, v110, v110 row_shr:2 row_mask:0xf bank_mask:0xf bound_ctrl:1
    v_add_u32_dpp v111, v111, v111 row_shr:2 row_mask:0xf bank_mask:0xf bound_ctrl:1
    v_add_u32_dpp v108, v108, v108 row_shr:4 row_mask:0xf bank_mask:0xf bound_ctrl:1
    v_add_u32_dpp v109, v109, v109 row_shr:4 row_mask:0xf bank_mask:0xf bound_ctrl:1
    v_add_u32_dpp v110, v110, v110 row_shr:4 row_mask:0xf bank_mask:0xf bound_ctrl:1
    v_add_u32_dpp v111, v111, v111 row_shr:4 row_mask:0xf bank_mask:0xf bound_ctrl:1
    v_add_u32_dpp v108, v108, v108 row_shr:8 row_mask:0xf bank_mask:0xf bound_ctrl:1
    v_add_u32_dpp v109, v109, v109 row_shr:8 row_mask:0xf bank_mask:0xf bound_ctrl:1
    v_add_u32_dpp v110, v110, v110 row_shr:8 row_mask:0xf bank_mask:0xf bound_ctrl:1
    v_add_u32_dpp v111, v111, v111 row_shr:8 row_mask:0xf bank_mask:0xf bound_ctrl:1
    v_add_u32_dpp v108, v108, v108 row_bcast:15 row_mask:0xa bank_mask:0xf
    v_add_u32_dpp v109, v109, v109 row_bcast:15 row_mask:0xa bank_mask:0xf
    v_add_u32_dpp v110, v110, v110 row_bcast:15 row_mask:0xa bank_mask:0xf
    v_add_u32_dpp v111, v111, v111 row_bcast:15 row_mask:0xa bank_mask:0xf
    v_add_u32_dpp v108, v108, v108 row_bcast:31 row_mask:0xc bank_mask:0xf
    v_add_u32_dpp v109, v109, v109 row_bcast:31 row_mask:0xc bank_mask:0xf
    v_add_u32_dpp v110, v110, v110 row_bcast:31 row_mask:0xc bank_mask:0xf
    v_add_u32_dpp v111, v111, v111 row_bcast:31 row_mask:0xc bank_mask:0xf
    v_add_u32 v88, v35, v34
    v_readlane_b32 s48, v108, 63
    v_readlane_b32 s49, v109, 63
    v_readlane_b32 s50, v110, 63
    v_readlane_b32 s51, v111, 63
    v_add_u32 v92, v88, v104
    v_add_u32 v96, v92, v105
    v_add_u32 v100, v96, v106
    s_add_u32 s49, s49, s48
    s_add_u32 s50, s50, s49
    s_add_u32 s35, s51, s50
    v_sub_u32 v89, v108, v104
    v_sub_u32 v93, v109, v105
    v_sub_u32 v97, v110, v106
    v_sub_u32 v101, v111, v107
    v_add_u32 v93, s48, v93
    v_add_u32 v97, s49, v97
    v_add_u32 v101, s50, v101
    v_mov_b32 v90, v104
    v_mov_b32 v94, v105
    v_mov_b32 v98, v106
    v_mov_b32 v102, v107
    v_mov_b32 v91, v35
    v_mov_b32 v95, v35
    v_mov_b32 v99, v35
    v_mov_b32 v103, v35
    v_and_b32 v113, 3, v88
    v_and_b32 v112, 0xfffffffc, v88
    v_lshlrev_b32 v112, 2, v112
    v_lshrrev_b32 v33, 16, v36
    v_add_u32 v113, v113, v33
    v_cmp_lt_u32 vcc, 32, v113
    s_cmp_le_u32 s35, 640
    s_cselect_b32 s54, 1, 0
    s_cmp_eq_u64 vcc, 0
    s_cselect_b32 s54, s54, 0
    v_lshlrev_b32 v32, 6, v1
    v_lshlrev_b32 v35, 3, v1
    v_mov_b32 v114, s35
    v_mov_b32 v115, s54
    v_mov_b32 v34, 4096
    ds_write_b128 v32, v[88:91] offset:0
    ds_write_b128 v32, v[92:95] offset:16
    ds_write_b128 v32, v[96:99] offset:32
    ds_write_b128 v32, v[100:103] offset:48
    ds_write_b64 v35, v[112:113] offset:4160
    ds_write_b64 v34, v[114:115]
    s_waitcnt lgkmcnt(0)
M_scan_done:
    v_lshlrev_b32 v32, 4, v0
    v_mov_b32 v34, 4096
    s_barrier
    ds_read_b128 v[36:39], v32 offset:0
    ds_read_b64 v[108:109], v34
    v_lshrrev_b32 v33, 3, v1
    s_lshl_b32 s38, s32, 7
    v_lshl_add_u32 v33, v33, 3, s38
    ds_read_b64 v[104:105], v33 offset:4160
    ds_read_b64 v[106:107], v33 offset:4224
    v_and_b32 v35, 7, v1
    v_lshlrev_b32 v35, 2, v35
    s_waitcnt lgkmcnt(0)
    v_readfirstlane_b32 s35, v108
    v_readfirstlane_b32 s54, v109
    s_mov_b32 s36, 0
    s_mov_b32 s43, 1
    s_mov_b32 s53, 1
    s_cmp_eq_u32 s35, 0
    s_cbranch_scc1 M_empty
    v_bfe_u32 v32, v1, 2, 2
    v_bfe_u32 v33, v1, 4, 1
    v_lshl_add_u32 v32, v3, 3, v32
    v_and_b32 v34, 3, v1
    v_lshlrev_b32 v32, 8, v32
    s_lshl_b32 s38, s32, 6
    v_lshl_add_u32 v32, v33, 5, v32
    v_lshl_add_u32 v32, v34, 3, v32
    v_add_u32 v55, s38, v32
    s_cmp_eq_u32 s54, 0
    s_cbranch_scc1 M_batch
    s_mov_b32 s52, 524288
    s_lshl_b32 s38, s32, 11
    v_cmp_lt_u32 vcc, v35, v105
    v_lshl_add_u32 v104, v35, 2, v104
    s_add_u32 m0, s38, 8192
    s_mov_b64 exec, vcc
    buffer_load_dwordx4 v104, s[20:23], s52 offen lds
    s_mov_b64 exec, -1
    v_cmp_lt_u32 vcc, v35, v107
    v_lshl_add_u32 v106, v35, 2, v106
    s_add_u32 m0, s38, 9216
    s_mov_b64 exec, vcc
    buffer_load_dwordx4 v106, s[20:23], s52 offen lds
    s_mov_b64 exec, -1
    v_lshlrev_b32 v154, 4, v1
    s_lshl_b32 s42, s32, 10
    s_add_u32 m0, s42, 32768
    s_add_u32 s42, s42, 393216
    buffer_load_dwordx4 v[56:59], v154, s[20:23], s42 offen
    v_lshrrev_b32 v152, 4, v0
    v_add_u32 v152, s33, v152
    v_and_b32 v153, 15, v0
    v_lshlrev_b32 v153, 4, v153
    buffer_load_dwordx4 v[152:153], s[12:15], 0 idxen offen lds
    s_mov_b32 s43, 0
    v_mov_b32 v42, 0
    v_mov_b32 v43, 0
    v_mov_b32 v44, 0
    v_mov_b32 v45, 0
    v_lshlrev_b32 v32, 4, v0
    v_cmp_gt_u32 vcc, 192, v0
    s_mov_b64 exec, vcc
    ds_write_b128 v32, v[42:45] offset:39936
    s_mov_b64 exec, -1
    s_mov_b32 s37, s35
    v_lshrrev_b32 v32, 2, v0
    v_lshlrev_b32 v32, 7, v32
    v_mov_b32_dpp v34, v36 quad_perm:[0,0,0,0] row_mask:0xf bank_mask:0xf
    v_and_b32 v34, 0xfffffffc, v34
    v_sub_u32 v34, v36, v34
    v_lshl_add_u32 v35, v34, 2, v32
    v_mov_b32 v45, v37
    v_lshlrev_b32 v44, 2, v37
    s_cmp_ge_u32 s32, 2
    s_cbranch_scc1 M_pad_donef
    v_add_u32 v32, s37, v0
    v_mov_b32 v34, 0xffffff
    v_lshlrev_b32 v33, 2, v32
    ds_write_b32 v33, v34 offset:43008
    ds_write_b32 v33, v34 offset:46080
    v_mov_b32 v34, 15
    ds_write_b8 v32, v34 offset:49152
M_pad_donef:
    v_lshrrev_b32 v32, 3, v1
    s_lshl_b32 s38, s32, 5
    v_lshlrev_b32 v32, 2, v32
    s_add_u32 s38, s38, 46080
    v_bfe_u32 v33, v1, 1, 3
    v_add_u32 v12, 43008, v32
    v_lshl_add_u32 v13, v33, 2, s38
    v_mov_b32 v14, v54
    s_waitcnt vmcnt(2)
M_fast_round:
    ds_read_b32 v46, v35 offset:8192
    ds_read_b32 v47, v35 offset:8196
    ds_read_b32 v48, v35 offset:8200
    ds_read_b32 v49, v35 offset:8204
    ds_read_b32 v50, v35 offset:8208
    ds_read_b32 v51, v35 offset:8212
    ds_read_b32 v52, v35 offset:8216
    ds_read_b32 v53, v35 offset:8220
    v_cmp_lt_i32 vcc, 0, v38
    s_mov_b64 exec, vcc
    s_cbranch_execz M_fast_done
    s_waitcnt lgkmcnt(0)
    v_and_b32 v32, 0x3fff, v46
    v_bfe_u32 v33, v46, 14, 5
    v_lshrrev_b32 v34, 19, v46
    v_add_u32 v34, v34, v39
    ds_write_b32 v44, v32 offset:43008
    ds_write_b8 v45, v33 offset:49152
    ds_write_b32 v44, v34 offset:46080
    v_cmp_lt_i32 vcc, 1, v38
    s_mov_b64 exec, vcc
    s_cbranch_execz M_fast_done
    v_and_b32 v32, 0x3fff, v47
    v_bfe_u32 v33, v47, 14, 5
    v_lshrrev_b32 v34, 19, v47
    v_add_u32 v34, v34, v39
    ds_write_b32 v44, v32 offset:43012
    ds_write_b8 v45, v33 offset:49153
    ds_write_b32 v44, v34 offset:46084
    v_cmp_lt_i32 vcc, 2, v38
    s_mov_b64 exec, vcc
    s_cbranch_execz M_fast_done
    v_and_b32 v32, 0x3fff, v48
    v_bfe_u32 v33, v48, 14, 5
    v_lshrrev_b32 v34, 19, v48
    v_add_u32 v34, v34, v39
    ds_write_b32 v44, v32 offset:43016
    ds_write_b8 v45, v33 offset:49154
    ds_write_b32 v44, v34 offset:46088
    v_cmp_lt_i32 vcc, 3, v38
    s_mov_b64 exec, vcc
    s_cbranch_execz M_fast_done
    v_and_b32 v32, 0x3fff, v49
    v_bfe_u32 v33, v49, 14, 5
    v_lshrrev_b32 v34, 19, v49
    v_add_u32 v34, v34, v39
    ds_write_b32 v44, v32 offset:43020
    ds_write_b8 v45, v33 offset:49155
    ds_write_b32 v44, v34 offset:46092
    v_cmp_lt_i32 vcc, 4, v38
    s_mov_b64 exec, vcc
    s_cbranch_execz M_fast_done
    v_and_b32 v32, 0x3fff, v50
    v_bfe_u32 v33, v50, 14, 5
    v_lshrrev_b32 v34, 19, v50
    v_add_u32 v34, v34, v39
    ds_write_b32 v44, v32 offset:43024
    ds_write_b8 v45, v33 offset:49156
    ds_write_b32 v44, v34 offset:46096
    v_cmp_lt_i32 vcc, 5, v38
    s_mov_b64 exec, vcc
    s_cbranch_execz M_fast_done
    v_and_b32 v32, 0x3fff, v51
    v_bfe_u32 v33, v51, 14, 5
    v_lshrrev_b32 v34, 19, v51
    v_add_u32 v34, v34, v39
    ds_write_b32 v44, v32 offset:43028
    ds_write_b8 v45, v33 offset:49157
    ds_write_b32 v44, v34 offset:46100
    v_cmp_lt_i32 vcc, 6, v38
    s_mov_b64 exec, vcc
    s_cbranch_execz M_fast_done
    v_and_b32 v32, 0x3fff, v52
    v_bfe_u32 v33, v52, 14, 5
    v_lshrrev_b32 v34, 19, v52
    v_add_u32 v34, v34, v39
    ds_write_b32 v44, v32 offset:43032
    ds_write_b8 v45, v33 offset:49158
    ds_write_b32 v44, v34 offset:46104
    v_cmp_lt_i32 vcc, 7, v38
    s_mov_b64 exec, vcc
    s_cbranch_execz M_fast_done
    v_and_b32 v32, 0x3fff, v53
    v_bfe_u32 v33, v53, 14, 5
    v_lshrrev_b32 v34, 19, v53
    v_add_u32 v34, v34, v39
    ds_write_b32 v44, v32 offset:43036
    ds_write_b8 v45, v33 offset:49159
    ds_write_b32 v44, v34 offset:46108
    s_mov_b64 exec, -1
    v_subrev_u32 v38, 8, v38
    v_add_u32 v35, 32, v35
    v_add_u32 v44, 32, v44
    v_add_u32 v45, 8, v45
    v_cmp_lt_i32 vcc, 0, v38
    s_cbranch_vccnz M_fast_round
M_fast_done:
    s_mov_b64 exec, -1
M_lists_done:
    s_waitcnt lgkmcnt(0)
    s_barrier
    ds_read_b32 v16, v12 offset:0
    ds_read_b32 v18, v12 offset:32
    ds_read_b32 v20, v12 offset:64
    ds_read_b32 v22, v12 offset:96
    ds_read_b32 v24, v13 offset:0
    v_subrev_u32 v32, 64, v14
    ds_read_u8 v26, v32
    ds_read_u8 v27, v32 offset:32
    s_waitcnt lgkmcnt(2)
    s_add_u32 m0, s40, 0
    s_nop 0
    buffer_load_dwordx4 v[16:17], s[24:27], 0 idxen offen  lds
    s_add_u32 m0, s40, 1024
    s_nop 0
    buffer_load_dwordx4 v[18:19], s[24:27], 0 idxen offen  lds
    s_add_u32 m0, s40, 2048
    s_nop 0
    buffer_load_dwordx4 v[20:21], s[24:27], 0 idxen offen  lds
    s_add_u32 m0, s40, 3072
    s_nop 0
    buffer_load_dwordx4 v[22:23], s[24:27], 0 idxen offen  lds
    s_add_u32 m0, s41, 0
    s_mov_b64 exec, 0xffff
    buffer_load_dwordx4 v[24:25], s[16:19], 0 idxen offen  lds
    s_mov_b64 exec, -1
    ds_read_b32 v16, v12 offset:128
    ds_read_b32 v18, v12 offset:160
    ds_read_b32 v20, v12 offset:192
    ds_read_b32 v22, v12 offset:224
    ds_read_b32 v24, v13 offset:128
    s_waitcnt lgkmcnt(0)
    s_add_u32 m0, s40, 4096
    s_nop 0
    buffer_load_dwordx4 v[16:17], s[24:27], 0 idxen offen  lds
    s_add_u32 m0, s40, 5120
    s_nop 0
    buffer_load_dwordx4 v[18:19], s[24:27], 0 idxen offen  lds
    s_add_u32 m0, s40, 6144
    s_nop 0
    buffer_load_dwordx4 v[20:21], s[24:27], 0 idxen offen  lds
    s_add_u32 m0, s40, 7168
    s_nop 0
    buffer_load_dwordx4 v[22:23], s[24:27], 0 idxen offen  lds
    s_add_u32 m0, s41, 1024
    s_mov_b64 exec, 0xffff
    buffer_load_dwordx4 v[24:25], s[16:19], 0 idxen offen  lds
    s_mov_b64 exec, -1
    s_waitcnt lgkmcnt(5)
    v_lshl_add_u32 v26, v26, 1, v30
    v_lshl_add_u32 v27, v27, 1, v31
    s_mov_b64 exec, 0xff
    ds_write_b16 v26, v28
    ds_write_b16 v27, v28
    s_mov_b64 exec, -1
    s_waitcnt vmcnt(5) lgkmcnt(0)
    s_barrier
    ds_read_b128 v[120:123], v4 offset:0
    ds_read_b128 v[124:127], v5 offset:0
    ds_read_b128 v[136:139], v8 offset:0
    ds_read_b128 v[140:143], v9 offset:0
    ds_read_b128 v[128:131], v6 offset:0
    ds_read_b128 v[132:135], v7 offset:0
    ds_read_b32 v16, v12 offset:256
    ds_read_b32 v18, v12 offset:288
    ds_read_b32 v20, v12 offset:320
    ds_read_b32 v22, v12 offset:352
    ds_read_b32 v24, v13 offset:256
    s_cmp_lg_u32 s36, 0
    s_cbranch_scc1 M_noxa
    ds_read_b64_tr_b16 v[60:61], v55 offset:32768
    ds_read_b64_tr_b16 v[62:63], v55 offset:33792
M_noxa:
    s_waitcnt lgkmcnt(0)
    s_add_u32 m0, s40, 0
    s_nop 0
    buffer_load_dwordx4 v[16:17], s[24:27], 0 idxen offen  lds
    s_add_u32 m0, s40, 1024
    s_nop 0
    buffer_load_dwordx4 v[18:19], s[24:27], 0 idxen offen  lds
    s_add_u32 s37, s37, 31
    s_lshr_b32 s37, s37, 5
M_loop:
    s_add_u32 m0, s40, 2048
    s_nop 0
    buffer_load_dwordx4 v[20:21], s[24:27], 0 idxen offen  lds
    s_waitcnt lgkmcnt(0)
    ds_read_b64_tr_b16 v[144:145], v10 offset:0
    ds_read_b64_tr_b16 v[146:147], v10 offset:256
    ds_read_b64_tr_b16 v[148:149], v10 offset:512
    ds_read_b64_tr_b16 v[150:151], v10 offset:768
    v_mfma_f32_32x32x16_bf16 v[88:103], v[120:123], v[64:67], 0
    v_mfma_f32_32x32x16_bf16 v[88:103], v[124:127], v[68:71], v[88:103]
    v_mfma_f32_32x32x16_bf16 v[88:103], v[136:139], v[56:59], v[88:103]
    v_mfma_f32_32x32x16_bf16 v[88:103], v[140:143], v[60:63], v[88:103]
    s_add_u32 m0, s40, 3072
    s_nop 0
    buffer_load_dwordx4 v[22:23], s[24:27], 0 idxen offen  lds
    v_mfma_f32_32x32x16_bf16 v[104:119], v[128:131], v[64:67], 0
    v_mfma_f32_32x32x16_bf16 v[104:119], v[132:135], v[68:71], v[104:119]
    s_add_u32 m0, s41, 2048
    s_mov_b64 exec, 0xffff
    buffer_load_dwordx4 v[24:25], s[16:19], 0 idxen offen  lds
    s_mov_b64 exec, -1
    s_waitcnt vmcnt(5) lgkmcnt(0)
    s_barrier
    ds_read_b128 v[120:123], v4 offset:4096
    ds_read_b128 v[124:127], v5 offset:4096
    ds_read_b128 v[136:139], v8 offset:1024
    ds_read_b128 v[140:143], v9 offset:1024
    ds_read_b128 v[128:131], v6 offset:4096
    ds_read_b128 v[132:135], v7 offset:4096
    ds_read_b32 v16, v12 offset:384
    ds_read_b32 v18, v12 offset:416
    ds_read_b32 v20, v12 offset:448
    ds_read_b32 v22, v12 offset:480
    ds_read_b32 v24, v13 offset:384
    ds_read_u8 v26, v14 offset:0
    v_exp_f32 v88, v88
    v_exp_f32 v89, v89
    v_exp_f32 v90, v90
    v_exp_f32 v91, v91
    v_exp_f32 v92, v92
    v_exp_f32 v93, v93
    v_exp_f32 v94, v94
    v_exp_f32 v95, v95
    v_exp_f32 v96, v96
    v_exp_f32 v97, v97
    v_exp_f32 v98, v98
    v_exp_f32 v99, v99
    v_exp_f32 v100, v100
    v_exp_f32 v101, v101
    v_exp_f32 v102, v102
    v_exp_f32 v103, v103
    s_setprio 0
    v_add_f32 v88, 1.0, v88
    v_add_f32 v89, 1.0, v89
    v_add_f32 v90, 1.0, v90
    v_add_f32 v91, 1.0, v91
    v_add_f32 v92, 1.0, v92
    v_add_f32 v93, 1.0, v93
    v_add_f32 v94, 1.0, v94
    v_add_f32 v95, 1.0, v95
    v_add_f32 v96, 1.0, v96
    v_add_f32 v97, 1.0, v97
    v_add_f32 v98, 1.0, v98
    v_add_f32 v99, 1.0, v99
    v_add_f32 v100, 1.0, v100
    v_add_f32 v101, 1.0, v101
    v_add_f32 v102, 1.0, v102
    v_add_f32 v103, 1.0, v103
    s_setprio 1
    s_waitcnt lgkmcnt(0)
    v_rcp_f32 v88, v88
    s_add_u32 m0, s40, 4096
    v_rcp_f32 v89, v89
    buffer_load_dwordx4 v[16:17], s[24:27], 0 idxen offen  lds
    v_rcp_f32 v90, v90
    v_rcp_f32 v91, v91
    v_rcp_f32 v92, v92
    v_rcp_f32 v93, v93
    v_rcp_f32 v94, v94
    v_rcp_f32 v95, v95
    v_rcp_f32 v96, v96
    s_add_u32 m0, s40, 5120
    v_rcp_f32 v97, v97
    buffer_load_dwordx4 v[18:19], s[24:27], 0 idxen offen  lds
    v_rcp_f32 v98, v98
    v_rcp_f32 v99, v99
    v_rcp_f32 v100, v100
    v_rcp_f32 v101, v101
    v_rcp_f32 v102, v102
    v_rcp_f32 v103, v103
    v_lshl_add_u32 v27, v26, 1, v29
    s_mov_b64 exec, 0xffff
    ds_write_b16 v27, v28
    s_mov_b64 exec, -1
    s_setprio 0
    v_mul_f32 v88, v88, v104
    v_mul_f32 v89, v89, v105
    v_mul_f32 v90, v90, v106
    v_mul_f32 v91, v91, v107
    v_mul_f32 v92, v92, v108
    v_mul_f32 v93, v93, v109
    v_mul_f32 v94, v94, v110
    v_mul_f32 v95, v95, v111
    v_mul_f32 v96, v96, v112
    v_mul_f32 v97, v97, v113
    v_mul_f32 v98, v98, v114
    v_mul_f32 v99, v99, v115
    v_mul_f32 v100, v100, v116
    v_mul_f32 v101, v101, v117
    v_mul_f32 v102, v102, v118
    v_mul_f32 v103, v103, v119
    s_setprio 1
    v_cvt_pk_bf16_f32 v152, v88, v89
    v_cvt_pk_bf16_f32 v153, v90, v91
    v_cvt_pk_bf16_f32 v154, v92, v93
    v_cvt_pk_bf16_f32 v155, v94, v95
    v_cvt_pk_bf16_f32 v156, v96, v97
    v_cvt_pk_bf16_f32 v157, v98, v99
    v_cvt_pk_bf16_f32 v158, v100, v101
    v_cvt_pk_bf16_f32 v159, v102, v103
    s_sub_u32 s37, s37, 1
    v_mfma_f32_32x32x16_bf16 v[72:87], v[144:147], v[152:155], v[72:87]
    v_mfma_f32_32x32x16_bf16 v[72:87], v[148:151], v[156:159], v[72:87]
    s_cmp_eq_u32 s37, 0
    s_cbranch_scc1 M_loop_done
    s_add_u32 m0, s40, 6144
    s_nop 0
    buffer_load_dwordx4 v[20:21], s[24:27], 0 idxen offen  lds
    s_waitcnt lgkmcnt(0)
    ds_read_b64_tr_b16 v[144:145], v10 offset:1024
    ds_read_b64_tr_b16 v[146:147], v10 offset:1280
    ds_read_b64_tr_b16 v[148:149], v10 offset:1536
    ds_read_b64_tr_b16 v[150:151], v10 offset:1792
    v_mfma_f32_32x32x16_bf16 v[88:103], v[120:123], v[64:67], 0
    v_mfma_f32_32x32x16_bf16 v[88:103], v[124:127], v[68:71], v[88:103]
    v_mfma_f32_32x32x16_bf16 v[88:103], v[136:139], v[56:59], v[88:103]
    v_mfma_f32_32x32x16_bf16 v[88:103], v[140:143], v[60:63], v[88:103]
    s_add_u32 m0, s40, 7168
    s_nop 0
    buffer_load_dwordx4 v[22:23], s[24:27], 0 idxen offen  lds
    v_mfma_f32_32x32x16_bf16 v[104:119], v[128:131], v[64:67], 0
    v_mfma_f32_32x32x16_bf16 v[104:119], v[132:135], v[68:71], v[104:119]
    s_add_u32 m0, s41, 0
    s_mov_b64 exec, 0xffff
    buffer_load_dwordx4 v[24:25], s[16:19], 0 idxen offen  lds
    s_mov_b64 exec, -1
    s_waitcnt vmcnt(5) lgkmcnt(0)
    s_barrier
    ds_read_b128 v[120:123], v4 offset:0
    ds_read_b128 v[124:127], v5 offset:0
    ds_read_b128 v[136:139], v8 offset:2048
    ds_read_b128 v[140:143], v9 offset:2048
    ds_read_b128 v[128:131], v6 offset:0
    ds_read_b128 v[132:135], v7 offset:0
    ds_read_b32 v16, v12 offset:512
    ds_read_b32 v18, v12 offset:544
    ds_read_b32 v20, v12 offset:576
    ds_read_b32 v22, v12 offset:608
    ds_read_b32 v24, v13 offset:512
    ds_read_u8 v26, v14 offset:32
    s_cmp_eq_u32 s53, 0
    s_cbranch_scc1 M_xu_done
    v_lshrrev_b32 v27, 4, v0
    v_add_u32 v27, s33, v27
    v_lshlrev_b32 v27, 8, v27
    v_and_b32 v160, 15, v0
    v_lshl_add_u32 v27, v160, 4, v27
    buffer_load_dwordx4 v[160:163], v27, s[44:47], 0 offen
    s_mov_b32 s53, 0
M_xu_done:
    v_exp_f32 v88, v88
    v_exp_f32 v89, v89
    v_exp_f32 v90, v90
    v_exp_f32 v91, v91
    v_exp_f32 v92, v92
    v_exp_f32 v93, v93
    v_exp_f32 v94, v94
    v_exp_f32 v95, v95
    v_exp_f32 v96, v96
    v_exp_f32 v97, v97
    v_exp_f32 v98, v98
    v_exp_f32 v99, v99
    v_exp_f32 v100, v100
    v_exp_f32 v101, v101
    v_exp_f32 v102, v102
    v_exp_f32 v103, v103
    s_setprio 0
    v_add_f32 v88, 1.0, v88
    v_add_f32 v89, 1.0, v89
    v_add_f32 v90, 1.0, v90
    v_add_f32 v91, 1.0, v91
    v_add_f32 v92, 1.0, v92
    v_add_f32 v93, 1.0, v93
    v_add_f32 v94, 1.0, v94
    v_add_f32 v95, 1.0, v95
    v_add_f32 v96, 1.0, v96
    v_add_f32 v97, 1.0, v97
    v_add_f32 v98, 1.0, v98
    v_add_f32 v99, 1.0, v99
    v_add_f32 v100, 1.0, v100
    v_add_f32 v101, 1.0, v101
    v_add_f32 v102, 1.0, v102
    v_add_f32 v103, 1.0, v103
    s_setprio 1
    s_waitcnt lgkmcnt(0)
    v_rcp_f32 v88, v88
    s_add_u32 m0, s40, 0
    v_rcp_f32 v89, v89
    buffer_load_dwordx4 v[16:17], s[24:27], 0 idxen offen  lds
    v_rcp_f32 v90, v90
    v_rcp_f32 v91, v91
    v_rcp_f32 v92, v92
    v_rcp_f32 v93, v93
    v_rcp_f32 v94, v94
    v_rcp_f32 v95, v95
    v_rcp_f32 v96, v96
    s_add_u32 m0, s40, 1024
    v_rcp_f32 v97, v97
    buffer_load_dwordx4 v[18:19], s[24:27], 0 idxen offen  lds
    v_rcp_f32 v98, v98
    v_rcp_f32 v99, v99
    v_rcp_f32 v100, v100
    v_rcp_f32 v101, v101
    v_rcp_f32 v102, v102
    v_rcp_f32 v103, v103
    v_lshl_add_u32 v27, v26, 1, v30
    s_mov_b64 exec, 0xffff
    ds_write_b16 v27, v28
    s_mov_b64 exec, -1
    s_setprio 0
    v_mul_f32 v88, v88, v104
    v_mul_f32 v89, v89, v105
    v_mul_f32 v90, v90, v106
    v_mul_f32 v91, v91, v107
    v_mul_f32 v92, v92, v108
    v_mul_f32 v93, v93, v109
    v_mul_f32 v94, v94, v110
    v_mul_f32 v95, v95, v111
    v_mul_f32 v96, v96, v112
    v_mul_f32 v97, v97, v113
    v_mul_f32 v98, v98, v114
    v_mul_f32 v99, v99, v115
    v_mul_f32 v100, v100, v116
    v_mul_f32 v101, v101, v117
    v_mul_f32 v102, v102, v118
    v_mul_f32 v103, v103, v119
    s_setprio 1
    v_cvt_pk_bf16_f32 v152, v88, v89
    v_cvt_pk_bf16_f32 v153, v90, v91
    v_cvt_pk_bf16_f32 v154, v92, v93
    v_cvt_pk_bf16_f32 v155, v94, v95
    v_cvt_pk_bf16_f32 v156, v96, v97
    v_cvt_pk_bf16_f32 v157, v98, v99
    v_cvt_pk_bf16_f32 v158, v100, v101
    v_cvt_pk_bf16_f32 v159, v102, v103
    s_sub_u32 s37, s37, 1
    v_mfma_f32_32x32x16_bf16 v[72:87], v[144:147], v[152:155], v[72:87]
    v_mfma_f32_32x32x16_bf16 v[72:87], v[148:151], v[156:159], v[72:87]
    s_cmp_eq_u32 s37, 0
    s_cbranch_scc1 M_loop_done
    s_add_u32 m0, s40, 2048
    s_nop 0
    buffer_load_dwordx4 v[20:21], s[24:27], 0 idxen offen  lds
    s_waitcnt lgkmcnt(0)
    ds_read_b64_tr_b16 v[144:145], v10 offset:2048
    ds_read_b64_tr_b16 v[146:147], v10 offset:2304
    ds_read_b64_tr_b16 v[148:149], v10 offset:2560
    ds_read_b64_tr_b16 v[150:151], v10 offset:2816
    v_mfma_f32_32x32x16_bf16 v[88:103], v[120:123], v[64:67], 0
    v_mfma_f32_32x32x16_bf16 v[88:103], v[124:127], v[68:71], v[88:103]
    v_mfma_f32_32x32x16_bf16 v[88:103], v[136:139], v[56:59], v[88:103]
    v_mfma_f32_32x32x16_bf16 v[88:103], v[140:143], v[60:63], v[88:103]
    s_add_u32 m0, s40, 3072
    s_nop 0
    buffer_load_dwordx4 v[22:23], s[24:27], 0 idxen offen  lds
    v_mfma_f32_32x32x16_bf16 v[104:119], v[128:131], v[64:67], 0
    v_mfma_f32_32x32x16_bf16 v[104:119], v[132:135], v[68:71], v[104:119]
    s_add_u32 m0, s41, 1024
    s_mov_b64 exec, 0xffff
    buffer_load_dwordx4 v[24:25], s[16:19], 0 idxen offen  lds
    s_mov_b64 exec, -1
    s_waitcnt vmcnt(5) lgkmcnt(0)
    s_barrier
    ds_read_b128 v[120:123], v4 offset:4096
    ds_read_b128 v[124:127], v5 offset:4096
    ds_read_b128 v[136:139], v8 offset:0
    ds_read_b128 v[140:143], v9 offset:0
    ds_read_b128 v[128:131], v6 offset:4096
    ds_read_b128 v[132:135], v7 offset:4096
    ds_read_b32 v16, v12 offset:640
    ds_read_b32 v18, v12 offset:672
    ds_read_b32 v20, v12 offset:704
    ds_read_b32 v22, v12 offset:736
    ds_read_b32 v24, v13 offset:640
    ds_read_u8 v26, v14 offset:64
    v_exp_f32 v88, v88
    v_exp_f32 v89, v89
    v_exp_f32 v90, v90
    v_exp_f32 v91, v91
    v_exp_f32 v92, v92
    v_exp_f32 v93, v93
    v_exp_f32 v94, v94
    v_exp_f32 v95, v95
    v_exp_f32 v96, v96
    v_exp_f32 v97, v97
    v_exp_f32 v98, v98
    v_exp_f32 v99, v99
    v_exp_f32 v100, v100
    v_exp_f32 v101, v101
    v_exp_f32 v102, v102
    v_exp_f32 v103, v103
    s_setprio 0
    v_add_f32 v88, 1.0, v88
    v_add_f32 v89, 1.0, v89
    v_add_f32 v90, 1.0, v90
    v_add_f32 v91, 1.0, v91
    v_add_f32 v92, 1.0, v92
    v_add_f32 v93, 1.0, v93
    v_add_f32 v94, 1.0, v94
    v_add_f32 v95, 1.0, v95
    v_add_f32 v96, 1.0, v96
    v_add_f32 v97, 1.0, v97
    v_add_f32 v98, 1.0, v98
    v_add_f32 v99, 1.0, v99
    v_add_f32 v100, 1.0, v100
    v_add_f32 v101, 1.0, v101
    v_add_f32 v102, 1.0, v102
    v_add_f32 v103, 1.0, v103
    s_setprio 1
    s_waitcnt lgkmcnt(0)
    v_rcp_f32 v88, v88
    s_add_u32 m0, s40, 4096
    v_rcp_f32 v89, v89
    buffer_load_dwordx4 v[16:17], s[24:27], 0 idxen offen  lds
    v_rcp_f32 v90, v90
    v_rcp_f32 v91, v91
    v_rcp_f32 v92, v92
    v_rcp_f32 v93, v93
    v_rcp_f32 v94, v94
    v_rcp_f32 v95, v95
    v_rcp_f32 v96, v96
    s_add_u32 m0, s40, 5120
    v_rcp_f32 v97, v97
    buffer_load_dwordx4 v[18:19], s[24:27], 0 idxen offen  lds
    v_rcp_f32 v98, v98
    v_rcp_f32 v99, v99
    v_rcp_f32 v100, v100
    v_rcp_f32 v101, v101
    v_rcp_f32 v102, v102
    v_rcp_f32 v103, v103
    v_lshl_add_u32 v27, v26, 1, v31
    s_mov_b64 exec, 0xffff
    ds_write_b16 v27, v28
    s_mov_b64 exec, -1
    s_setprio 0
    v_mul_f32 v88, v88, v104
    v_mul_f32 v89, v89, v105
    v_mul_f32 v90, v90, v106
    v_mul_f32 v91, v91, v107
    v_mul_f32 v92, v92, v108
    v_mul_f32 v93, v93, v109
    v_mul_f32 v94, v94, v110
    v_mul_f32 v95, v95, v111
    v_mul_f32 v96, v96, v112
    v_mul_f32 v97, v97, v113
    v_mul_f32 v98, v98, v114
    v_mul_f32 v99, v99, v115
    v_mul_f32 v100, v100, v116
    v_mul_f32 v101, v101, v117
    v_mul_f32 v102, v102, v118
    v_mul_f32 v103, v103, v119
    s_setprio 1
    v_cvt_pk_bf16_f32 v152, v88, v89
    v_cvt_pk_bf16_f32 v153, v90, v91
    v_cvt_pk_bf16_f32 v154, v92, v93
    v_cvt_pk_bf16_f32 v155, v94, v95
    v_cvt_pk_bf16_f32 v156, v96, v97
    v_cvt_pk_bf16_f32 v157, v98, v99
    v_cvt_pk_bf16_f32 v158, v100, v101
    v_cvt_pk_bf16_f32 v159, v102, v103
    s_sub_u32 s37, s37, 1
    v_mfma_f32_32x32x16_bf16 v[72:87], v[144:147], v[152:155], v[72:87]
    v_mfma_f32_32x32x16_bf16 v[72:87], v[148:151], v[156:159], v[72:87]
    s_cmp_eq_u32 s37, 0
    s_cbranch_scc1 M_loop_done
    s_add_u32 m0, s40, 6144
    s_nop 0
    buffer_load_dwordx4 v[20:21], s[24:27], 0 idxen offen  lds
    s_waitcnt lgkmcnt(0)
    ds_read_b64_tr_b16 v[144:145], v10 offset:0
    ds_read_b64_tr_b16 v[146:147], v10 offset:256
    ds_read_b64_tr_b16 v[148:149], v10 offset:512
    ds_read_b64_tr_b16 v[150:151], v10 offset:768
    v_mfma_f32_32x32x16_bf16 v[88:103], v[120:123], v[64:67], 0
    v_mfma_f32_32x32x16_bf16 v[88:103], v[124:127], v[68:71], v[88:103]
    v_mfma_f32_32x32x16_bf16 v[88:103], v[136:139], v[56:59], v[88:103]
    v_mfma_f32_32x32x16_bf16 v[88:103], v[140:143], v[60:63], v[88:103]
    s_add_u32 m0, s40, 7168
    s_nop 0
    buffer_load_dwordx4 v[22:23], s[24:27], 0 idxen offen  lds
    v_mfma_f32_32x32x16_bf16 v[104:119], v[128:131], v[64:67], 0
    v_mfma_f32_32x32x16_bf16 v[104:119], v[132:135], v[68:71], v[104:119]
    s_add_u32 m0, s41, 2048
    s_mov_b64 exec, 0xffff
    buffer_load_dwordx4 v[24:25], s[16:19], 0 idxen offen  lds
    s_mov_b64 exec, -1
    s_waitcnt vmcnt(5) lgkmcnt(0)
    s_barrier
    ds_read_b128 v[120:123], v4 offset:0
    ds_read_b128 v[124:127], v5 offset:0
    ds_read_b128 v[136:139], v8 offset:1024
    ds_read_b128 v[140:143], v9 offset:1024
    ds_read_b128 v[128:131], v6 offset:0
    ds_read_b128 v[132:135], v7 offset:0
    ds_read_b32 v16, v12 offset:768
    ds_read_b32 v18, v12 offset:800
    ds_read_b32 v20, v12 offset:832
    ds_read_b32 v22, v12 offset:864
    ds_read_b32 v24, v13 offset:768
    ds_read_u8 v26, v14 offset:96
    v_exp_f32 v88, v88
    v_exp_f32 v89, v89
    v_exp_f32 v90, v90
    v_exp_f32 v91, v91
    v_exp_f32 v92, v92
    v_exp_f32 v93, v93
    v_exp_f32 v94, v94
    v_exp_f32 v95, v95
    v_exp_f32 v96, v96
    v_exp_f32 v97, v97
    v_exp_f32 v98, v98
    v_exp_f32 v99, v99
    v_exp_f32 v100, v100
    v_exp_f32 v101, v101
    v_exp_f32 v102, v102
    v_exp_f32 v103, v103
    s_setprio 0
    v_add_f32 v88, 1.0, v88
    v_add_f32 v89, 1.0, v89
    v_add_f32 v90, 1.0, v90
    v_add_f32 v91, 1.0, v91
    v_add_f32 v92, 1.0, v92
    v_add_f32 v93, 1.0, v93
    v_add_f32 v94, 1.0, v94
    v_add_f32 v95, 1.0, v95
    v_add_f32 v96, 1.0, v96
    v_add_f32 v97, 1.0, v97
    v_add_f32 v98, 1.0, v98
    v_add_f32 v99, 1.0, v99
    v_add_f32 v100, 1.0, v100
    v_add_f32 v101, 1.0, v101
    v_add_f32 v102, 1.0, v102
    v_add_f32 v103, 1.0, v103
    s_setprio 1
    s_waitcnt lgkmcnt(0)
    v_rcp_f32 v88, v88
    s_add_u32 m0, s40, 0
    v_rcp_f32 v89, v89
    buffer_load_dwordx4 v[16:17], s[24:27], 0 idxen offen  lds
    v_rcp_f32 v90, v90
    v_rcp_f32 v91, v91
    v_rcp_f32 v92, v92
    v_rcp_f32 v93, v93
    v_rcp_f32 v94, v94
    v_rcp_f32 v95, v95
    v_rcp_f32 v96, v96
    s_add_u32 m0, s40, 1024
    v_rcp_f32 v97, v97
    buffer_load_dwordx4 v[18:19], s[24:27], 0 idxen offen  lds
    v_rcp_f32 v98, v98
    v_rcp_f32 v99, v99
    v_rcp_f32 v100, v100
    v_rcp_f32 v101, v101
    v_rcp_f32 v102, v102
    v_rcp_f32 v103, v103
    v_lshl_add_u32 v27, v26, 1, v29
    s_mov_b64 exec, 0xffff
    ds_write_b16 v27, v28
    s_mov_b64 exec, -1
    s_setprio 0
    v_mul_f32 v88, v88, v104
    v_mul_f32 v89, v89, v105
    v_mul_f32 v90, v90, v106
    v_mul_f32 v91, v91, v107
    v_mul_f32 v92, v92, v108
    v_mul_f32 v93, v93, v109
    v_mul_f32 v94, v94, v110
    v_mul_f32 v95, v95, v111
    v_mul_f32 v96, v96, v112
    v_mul_f32 v97, v97, v113
    v_mul_f32 v98, v98, v114
    v_mul_f32 v99, v99, v115
    v_mul_f32 v100, v100, v116
    v_mul_f32 v101, v101, v117
    v_mul_f32 v102, v102, v118
    v_mul_f32 v103, v103, v119
    s_setprio 1
    v_cvt_pk_bf16_f32 v152, v88, v89
    v_cvt_pk_bf16_f32 v153, v90, v91
    v_cvt_pk_bf16_f32 v154, v92, v93
    v_cvt_pk_bf16_f32 v155, v94, v95
    v_cvt_pk_bf16_f32 v156, v96, v97
    v_cvt_pk_bf16_f32 v157, v98, v99
    v_cvt_pk_bf16_f32 v158, v100, v101
    v_cvt_pk_bf16_f32 v159, v102, v103
    s_sub_u32 s37, s37, 1
    v_mfma_f32_32x32x16_bf16 v[72:87], v[144:147], v[152:155], v[72:87]
    v_mfma_f32_32x32x16_bf16 v[72:87], v[148:151], v[156:159], v[72:87]
    s_cmp_eq_u32 s37, 0
    s_cbranch_scc1 M_loop_done
    s_add_u32 m0, s40, 2048
    s_nop 0
    buffer_load_dwordx4 v[20:21], s[24:27], 0 idxen offen  lds
    s_waitcnt lgkmcnt(0)
    ds_read_b64_tr_b16 v[144:145], v10 offset:1024
    ds_read_b64_tr_b16 v[146:147], v10 offset:1280
    ds_read_b64_tr_b16 v[148:149], v10 offset:1536
    ds_read_b64_tr_b16 v[150:151], v10 offset:1792
    v_mfma_f32_32x32x16_bf16 v[88:103], v[120:123], v[64:67], 0
    v_mfma_f32_32x32x16_bf16 v[88:103], v[124:127], v[68:71], v[88:103]
    v_mfma_f32_32x32x16_bf16 v[88:103], v[136:139], v[56:59], v[88:103]
    v_mfma_f32_32x32x16_bf16 v[88:103], v[140:143], v[60:63], v[88:103]
    s_add_u32 m0, s40, 3072
    s_nop 0
    buffer_load_dwordx4 v[22:23], s[24:27], 0 idxen offen  lds
    v_mfma_f32_32x32x16_bf16 v[104:119], v[128:131], v[64:67], 0
    v_mfma_f32_32x32x16_bf16 v[104:119], v[132:135], v[68:71], v[104:119]
    s_add_u32 m0, s41, 0
    s_mov_b64 exec, 0xffff
    buffer_load_dwordx4 v[24:25], s[16:19], 0 idxen offen  lds
    s_mov_b64 exec, -1
    s_waitcnt vmcnt(5) lgkmcnt(0)
    s_barrier
    ds_read_b128 v[120:123], v4 offset:4096
    ds_read_b128 v[124:127], v5 offset:4096
    ds_read_b128 v[136:139], v8 offset:2048
    ds_read_b128 v[140:143], v9 offset:2048
    ds_read_b128 v[128:131], v6 offset:4096
    ds_read_b128 v[132:135], v7 offset:4096
    ds_read_b32 v16, v12 offset:896
    ds_read_b32 v18, v12 offset:928
    ds_read_b32 v20, v12 offset:960
    ds_read_b32 v22, v12 offset:992
    ds_read_b32 v24, v13 offset:896
    ds_read_u8 v26, v14 offset:128
    v_exp_f32 v88, v88
    v_exp_f32 v89, v89
    v_exp_f32 v90, v90
    v_exp_f32 v91, v91
    v_exp_f32 v92, v92
    v_exp_f32 v93, v93
    v_exp_f32 v94, v94
    v_exp_f32 v95, v95
    v_exp_f32 v96, v96
    v_exp_f32 v97, v97
    v_exp_f32 v98, v98
    v_exp_f32 v99, v99
    v_exp_f32 v100, v100
    v_exp_f32 v101, v101
    v_exp_f32 v102, v102
    v_exp_f32 v103, v103
    s_setprio 0
    v_add_f32 v88, 1.0, v88
    v_add_f32 v89, 1.0, v89
    v_add_f32 v90, 1.0, v90
    v_add_f32 v91, 1.0, v91
    v_add_f32 v92, 1.0, v92
    v_add_f32 v93, 1.0, v93
    v_add_f32 v94, 1.0, v94
    v_add_f32 v95, 1.0, v95
    v_add_f32 v96, 1.0, v96
    v_add_f32 v97, 1.0, v97
    v_add_f32 v98, 1.0, v98
    v_add_f32 v99, 1.0, v99
    v_add_f32 v100, 1.0, v100
    v_add_f32 v101, 1.0, v101
    v_add_f32 v102, 1.0, v102
    v_add_f32 v103, 1.0, v103
    s_setprio 1
    s_waitcnt lgkmcnt(0)
    v_rcp_f32 v88, v88
    s_add_u32 m0, s40, 4096
    v_rcp_f32 v89, v89
    buffer_load_dwordx4 v[16:17], s[24:27], 0 idxen offen  lds
    v_rcp_f32 v90, v90
    v_rcp_f32 v91, v91
    v_rcp_f32 v92, v92
    v_rcp_f32 v93, v93
    v_rcp_f32 v94, v94
    v_rcp_f32 v95, v95
    v_rcp_f32 v96, v96
    s_add_u32 m0, s40, 5120
    v_rcp_f32 v97, v97
    buffer_load_dwordx4 v[18:19], s[24:27], 0 idxen offen  lds
    v_rcp_f32 v98, v98
    v_rcp_f32 v99, v99
    v_rcp_f32 v100, v100
    v_rcp_f32 v101, v101
    v_rcp_f32 v102, v102
    v_rcp_f32 v103, v103
    v_lshl_add_u32 v27, v26, 1, v30
    s_mov_b64 exec, 0xffff
    ds_write_b16 v27, v28
    s_mov_b64 exec, -1
    s_setprio 0
    v_mul_f32 v88, v88, v104
    v_mul_f32 v89, v89, v105
    v_mul_f32 v90, v90, v106
    v_mul_f32 v91, v91, v107
    v_mul_f32 v92, v92, v108
    v_mul_f32 v93, v93, v109
    v_mul_f32 v94, v94, v110
    v_mul_f32 v95, v95, v111
    v_mul_f32 v96, v96, v112
    v_mul_f32 v97, v97, v113
    v_mul_f32 v98, v98, v114
    v_mul_f32 v99, v99, v115
    v_mul_f32 v100, v100, v116
    v_mul_f32 v101, v101, v117
    v_mul_f32 v102, v102, v118
    v_mul_f32 v103, v103, v119
    s_setprio 1
    v_cvt_pk_bf16_f32 v152, v88, v89
    v_cvt_pk_bf16_f32 v153, v90, v91
    v_cvt_pk_bf16_f32 v154, v92, v93
    v_cvt_pk_bf16_f32 v155, v94, v95
    v_cvt_pk_bf16_f32 v156, v96, v97
    v_cvt_pk_bf16_f32 v157, v98, v99
    v_cvt_pk_bf16_f32 v158, v100, v101
    v_cvt_pk_bf16_f32 v159, v102, v103
    s_sub_u32 s37, s37, 1
    v_mfma_f32_32x32x16_bf16 v[72:87], v[144:147], v[152:155], v[72:87]
    v_mfma_f32_32x32x16_bf16 v[72:87], v[148:151], v[156:159], v[72:87]
    s_cmp_eq_u32 s37, 0
    s_cbranch_scc1 M_loop_done
    s_add_u32 m0, s40, 6144
    s_nop 0
    buffer_load_dwordx4 v[20:21], s[24:27], 0 idxen offen  lds
    s_waitcnt lgkmcnt(0)
    ds_read_b64_tr_b16 v[144:145], v10 offset:2048
    ds_read_b64_tr_b16 v[146:147], v10 offset:2304
    ds_read_b64_tr_b16 v[148:149], v10 offset:2560
    ds_read_b64_tr_b16 v[150:151], v10 offset:2816
    v_mfma_f32_32x32x16_bf16 v[88:103], v[120:123], v[64:67], 0
    v_mfma_f32_32x32x16_bf16 v[88:103], v[124:127], v[68:71], v[88:103]
    v_mfma_f32_32x32x16_bf16 v[88:103], v[136:139], v[56:59], v[88:103]
    v_mfma_f32_32x32x16_bf16 v[88:103], v[140:143], v[60:63], v[88:103]
    s_add_u32 m0, s40, 7168
    s_nop 0
    buffer_load_dwordx4 v[22:23], s[24:27], 0 idxen offen  lds
    v_mfma_f32_32x32x16_bf16 v[104:119], v[128:131], v[64:67], 0
    v_mfma_f32_32x32x16_bf16 v[104:119], v[132:135], v[68:71], v[104:119]
    s_add_u32 m0, s41, 1024
    s_mov_b64 exec, 0xffff
    buffer_load_dwordx4 v[24:25], s[16:19], 0 idxen offen  lds
    s_mov_b64 exec, -1
    s_waitcnt vmcnt(5) lgkmcnt(0)
    s_barrier
    ds_read_b128 v[120:123], v4 offset:0
    ds_read_b128 v[124:127], v5 offset:0
    ds_read_b128 v[136:139], v8 offset:0
    ds_read_b128 v[140:143], v9 offset:0
    ds_read_b128 v[128:131], v6 offset:0
    ds_read_b128 v[132:135], v7 offset:0
    ds_read_b32 v16, v12 offset:1024
    ds_read_b32 v18, v12 offset:1056
    ds_read_b32 v20, v12 offset:1088
    ds_read_b32 v22, v12 offset:1120
    ds_read_b32 v24, v13 offset:1024
    ds_read_u8 v26, v14 offset:160
    v_exp_f32 v88, v88
    v_exp_f32 v89, v89
    v_exp_f32 v90, v90
    v_exp_f32 v91, v91
    v_exp_f32 v92, v92
    v_exp_f32 v93, v93
    v_exp_f32 v94, v94
    v_exp_f32 v95, v95
    v_exp_f32 v96, v96
    v_exp_f32 v97, v97
    v_exp_f32 v98, v98
    v_exp_f32 v99, v99
    v_exp_f32 v100, v100
    v_exp_f32 v101, v101
    v_exp_f32 v102, v102
    v_exp_f32 v103, v103
    s_setprio 0
    v_add_f32 v88, 1.0, v88
    v_add_f32 v89, 1.0, v89
    v_add_f32 v90, 1.0, v90
    v_add_f32 v91, 1.0, v91
    v_add_f32 v92, 1.0, v92
    v_add_f32 v93, 1.0, v93
    v_add_f32 v94, 1.0, v94
    v_add_f32 v95, 1.0, v95
    v_add_f32 v96, 1.0, v96
    v_add_f32 v97, 1.0, v97
    v_add_f32 v98, 1.0, v98
    v_add_f32 v99, 1.0, v99
    v_add_f32 v100, 1.0, v100
    v_add_f32 v101, 1.0, v101
    v_add_f32 v102, 1.0, v102
    v_add_f32 v103, 1.0, v103
    s_setprio 1
    s_waitcnt lgkmcnt(0)
    v_rcp_f32 v88, v88
    s_add_u32 m0, s40, 0
    v_rcp_f32 v89, v89
    buffer_load_dwordx4 v[16:17], s[24:27], 0 idxen offen  lds
    v_rcp_f32 v90, v90
    v_rcp_f32 v91, v91
    v_rcp_f32 v92, v92
    v_rcp_f32 v93, v93
    v_rcp_f32 v94, v94
    v_rcp_f32 v95, v95
    v_rcp_f32 v96, v96
    s_add_u32 m0, s40, 1024
    v_rcp_f32 v97, v97
    buffer_load_dwordx4 v[18:19], s[24:27], 0 idxen offen  lds
    v_rcp_f32 v98, v98
    v_rcp_f32 v99, v99
    v_rcp_f32 v100, v100
    v_rcp_f32 v101, v101
    v_rcp_f32 v102, v102
    v_rcp_f32 v103, v103
    v_lshl_add_u32 v27, v26, 1, v31
    s_mov_b64 exec, 0xffff
    ds_write_b16 v27, v28
    s_mov_b64 exec, -1
    s_setprio 0
    v_mul_f32 v88, v88, v104
    v_mul_f32 v89, v89, v105
    v_mul_f32 v90, v90, v106
    v_mul_f32 v91, v91, v107
    v_mul_f32 v92, v92, v108
    v_mul_f32 v93, v93, v109
    v_mul_f32 v94, v94, v110
    v_mul_f32 v95, v95, v111
    v_mul_f32 v96, v96, v112
    v_mul_f32 v97, v97, v113
    v_mul_f32 v98, v98, v114
    v_mul_f32 v99, v99, v115
    v_mul_f32 v100, v100, v116
    v_mul_f32 v101, v101, v117
    v_mul_f32 v102, v102, v118
    v_mul_f32 v103, v103, v119
    s_setprio 1
    v_cvt_pk_bf16_f32 v152, v88, v89
    v_cvt_pk_bf16_f32 v153, v90, v91
    v_cvt_pk_bf16_f32 v154, v92, v93
    v_cvt_pk_bf16_f32 v155, v94, v95
    v_cvt_pk_bf16_f32 v156, v96, v97
    v_cvt_pk_bf16_f32 v157, v98, v99
    v_cvt_pk_bf16_f32 v158, v100, v101
    v_cvt_pk_bf16_f32 v159, v102, v103
    s_sub_u32 s37, s37, 1
    v_mfma_f32_32x32x16_bf16 v[72:87], v[144:147], v[152:155], v[72:87]
    v_mfma_f32_32x32x16_bf16 v[72:87], v[148:151], v[156:159], v[72:87]
    s_cmp_eq_u32 s37, 0
    s_cbranch_scc1 M_loop_done
    v_add_u32 v12, 768, v12
    v_add_u32 v13, 768, v13
    v_add_u32 v14, 192, v14
    s_branch M_loop
M_loop_done:
    s_cmp_eq_u32 s53, 0
    s_cbranch_scc1 M_xu_done2
    v_lshrrev_b32 v27, 4, v0
    v_add_u32 v27, s33, v27
    v_lshlrev_b32 v27, 8, v27
    v_and_b32 v160, 15, v0
    v_lshl_add_u32 v27, v160, 4, v27
    buffer_load_dwordx4 v[160:163], v27, s[44:47], 0 offen
    s_mov_b32 s53, 0
M_xu_done2:
    s_waitcnt vmcnt(0) lgkmcnt(0)
    s_barrier
    s_add_u32 s36, s36, 640
    s_cmp_lt_u32 s36, s35
    s_cbranch_scc1 M_batch
M_epilogue:
    v_mul_u32_u24 v32, 2112, v3
    v_lshl_add_u32 v32, v2, 2, v32
    s_lshl_b32 s39, s32, 7
    v_add_u32 v32, s39, v32
    s_nop 7
    ds_write_b32 v32, v72 offset:0
    ds_write_b32 v32, v73 offset:528
    ds_write_b32 v32, v74 offset:1056
    ds_write_b32 v32, v75 offset:1584
    ds_write_b32 v32, v76 offset:4224
    ds_write_b32 v32, v77 offset:4752
    ds_write_b32 v32, v78 offset:5280
    ds_write_b32 v32, v79 offset:5808
    v_lshrrev_b32 v32, 4, v0
    v_and_b32 v33, 15, v0
    v_mul_u32_u24 v34, 528, v32
    v_lshl_add_u32 v34, v33, 5, v34
    v_add_u32 v35, s33, v32
    v_lshlrev_b32 v35, 8, v35
    v_lshl_add_u32 v35, v33, 4, v35
    s_mov_b32 s38, 0xbfb8aa3b
    s_waitcnt lgkmcnt(0)
    s_barrier
    ds_read_b128 v[88:91], v34 offset:0
    ds_read_b128 v[92:95], v34 offset:16
    v_lshlrev_b32 v104, 16, v160
    v_and_b32 v105, 0xffff0000, v160
    v_lshlrev_b32 v106, 16, v161
    v_and_b32 v107, 0xffff0000, v161
    v_lshlrev_b32 v108, 16, v162
    v_and_b32 v109, 0xffff0000, v162
    v_lshlrev_b32 v110, 16, v163
    v_and_b32 v111, 0xffff0000, v163
    s_waitcnt lgkmcnt(0)
    v_add_f32 v88, v88, v104
    v_add_f32 v89, v89, v105
    v_add_f32 v90, v90, v106
    v_add_f32 v91, v91, v107
    v_add_f32 v92, v92, v108
    v_add_f32 v93, v93, v109
    v_add_f32 v94, v94, v110
    v_add_f32 v95, v95, v111
    v_mul_f32 v104, s38, v88
    v_mul_f32 v105, s38, v89
    v_mul_f32 v106, s38, v90
    v_mul_f32 v107, s38, v91
    v_mul_f32 v108, s38, v92
    v_mul_f32 v109, s38, v93
    v_mul_f32 v110, s38, v94
    v_mul_f32 v111, s38, v95
    v_exp_f32 v104, v104
    v_exp_f32 v105, v105
    v_exp_f32 v106, v106
    v_exp_f32 v107, v107
    v_exp_f32 v108, v108
    v_exp_f32 v109, v109
    v_exp_f32 v110, v110
    v_exp_f32 v111, v111
    v_add_f32 v104, 1.0, v104
    v_add_f32 v105, 1.0, v105
    v_add_f32 v106, 1.0, v106
    v_add_f32 v107, 1.0, v107
    v_add_f32 v108, 1.0, v108
    v_add_f32 v109, 1.0, v109
    v_add_f32 v110, 1.0, v110
    v_add_f32 v111, 1.0, v111
    v_rcp_f32 v104, v104
    v_rcp_f32 v105, v105
    v_rcp_f32 v106, v106
    v_rcp_f32 v107, v107
    v_rcp_f32 v108, v108
    v_rcp_f32 v109, v109
    v_rcp_f32 v110, v110
    v_rcp_f32 v111, v111
    s_nop 0
    v_mul_f32 v88, v88, v104
    v_mul_f32 v89, v89, v105
    v_mul_f32 v90, v90, v106
    v_mul_f32 v91, v91, v107
    v_mul_f32 v92, v92, v108
    v_mul_f32 v93, v93, v109
    v_mul_f32 v94, v94, v110
    v_mul_f32 v95, v95, v111
    v_cvt_pk_bf16_f32 v152, v88, v89
    v_cvt_pk_bf16_f32 v153, v90, v91
    v_cvt_pk_bf16_f32 v154, v92, v93
    v_cvt_pk_bf16_f32 v155, v94, v95
    v_cmp_gt_u32 vcc, s34, v32
    s_mov_b64 exec, vcc
    s_cbranch_execz M_end
    buffer_store_dwordx4 v[152:155], v35, s[28:31], 0 offen sc1
M_end:
    s_endpgm
M_batch:
    v_mov_b32 v42, 0
    v_mov_b32 v43, 0
    v_mov_b32 v44, 0
    v_mov_b32 v45, 0
    v_lshlrev_b32 v32, 4, v0
    v_cmp_gt_u32 vcc, 192, v0
    s_mov_b64 exec, vcc
    ds_write_b128 v32, v[42:45] offset:39936
    s_mov_b64 exec, -1
    s_sub_u32 s37, s35, s36
    s_min_u32 s37, s37, 640
    v_sub_u32 v42, s36, v37
    v_add_u32 v43, 640, v42
    v_max_i32 v42, 0, v42
    v_min_i32 v43, v43, v38
    v_sub_u32 v43, v43, v42
    v_add_lshl_u32 v35, v42, v36, 2
    v_add_u32 v45, v37, v42
    v_subrev_u32 v45, s36, v45
    v_lshlrev_b32 v44, 2, v45
    s_mov_b32 s52, 524288
M_round:
    v_cmp_lt_i32 vcc, 0, v43
    s_mov_b64 exec, vcc
    s_cbranch_execz M_round_issued
    buffer_load_dwordx4 v[46:49], v35, s[20:23], s52 offen offset:0
    v_cmp_lt_i32 vcc, 4, v43
    s_mov_b64 exec, vcc
    s_cbranch_execz M_round_issued
    buffer_load_dwordx4 v[50:53], v35, s[20:23], s52 offen offset:16
M_round_issued:
    s_mov_b64 exec, -1
    s_cmp_eq_u32 s43, 0
    s_cbranch_scc1 M_round_w0
    v_lshlrev_b32 v154, 4, v1
    s_lshl_b32 s42, s32, 10
    s_add_u32 m0, s42, 32768
    s_add_u32 s42, s42, 393216
    buffer_load_dwordx4 v[56:59], v154, s[20:23], s42 offen
    v_lshrrev_b32 v152, 4, v0
    v_add_u32 v152, s33, v152
    v_and_b32 v153, 15, v0
    v_lshlrev_b32 v153, 4, v153
    buffer_load_dwordx4 v[152:153], s[12:15], 0 idxen offen lds
    s_mov_b32 s43, 0
    s_waitcnt vmcnt(2)
    s_branch M_round_proc
M_round_w0:
    s_waitcnt vmcnt(0)
M_round_proc:
    v_cmp_lt_i32 vcc, 0, v43
    s_mov_b64 exec, vcc
    s_cbranch_execz M_round_done
    v_and_b32 v32, 0x3fff, v46
    v_bfe_u32 v33, v46, 14, 5
    v_lshrrev_b32 v34, 19, v46
    v_add_u32 v34, v34, v39
    ds_write_b32 v44, v32 offset:43008
    ds_write_b8 v45, v33 offset:49152
    ds_write_b32 v44, v34 offset:46080
    v_cmp_lt_i32 vcc, 1, v43
    s_mov_b64 exec, vcc
    s_cbranch_execz M_round_done
    v_and_b32 v32, 0x3fff, v47
    v_bfe_u32 v33, v47, 14, 5
    v_lshrrev_b32 v34, 19, v47
    v_add_u32 v34, v34, v39
    ds_write_b32 v44, v32 offset:43012
    ds_write_b8 v45, v33 offset:49153
    ds_write_b32 v44, v34 offset:46084
    v_cmp_lt_i32 vcc, 2, v43
    s_mov_b64 exec, vcc
    s_cbranch_execz M_round_done
    v_and_b32 v32, 0x3fff, v48
    v_bfe_u32 v33, v48, 14, 5
    v_lshrrev_b32 v34, 19, v48
    v_add_u32 v34, v34, v39
    ds_write_b32 v44, v32 offset:43016
    ds_write_b8 v45, v33 offset:49154
    ds_write_b32 v44, v34 offset:46088
    v_cmp_lt_i32 vcc, 3, v43
    s_mov_b64 exec, vcc
    s_cbranch_execz M_round_done
    v_and_b32 v32, 0x3fff, v49
    v_bfe_u32 v33, v49, 14, 5
    v_lshrrev_b32 v34, 19, v49
    v_add_u32 v34, v34, v39
    ds_write_b32 v44, v32 offset:43020
    ds_write_b8 v45, v33 offset:49155
    ds_write_b32 v44, v34 offset:46092
    v_cmp_lt_i32 vcc, 4, v43
    s_mov_b64 exec, vcc
    s_cbranch_execz M_round_done
    v_and_b32 v32, 0x3fff, v50
    v_bfe_u32 v33, v50, 14, 5
    v_lshrrev_b32 v34, 19, v50
    v_add_u32 v34, v34, v39
    ds_write_b32 v44, v32 offset:43024
    ds_write_b8 v45, v33 offset:49156
    ds_write_b32 v44, v34 offset:46096
    v_cmp_lt_i32 vcc, 5, v43
    s_mov_b64 exec, vcc
    s_cbranch_execz M_round_done
    v_and_b32 v32, 0x3fff, v51
    v_bfe_u32 v33, v51, 14, 5
    v_lshrrev_b32 v34, 19, v51
    v_add_u32 v34, v34, v39
    ds_write_b32 v44, v32 offset:43028
    ds_write_b8 v45, v33 offset:49157
    ds_write_b32 v44, v34 offset:46100
    v_cmp_lt_i32 vcc, 6, v43
    s_mov_b64 exec, vcc
    s_cbranch_execz M_round_done
    v_and_b32 v32, 0x3fff, v52
    v_bfe_u32 v33, v52, 14, 5
    v_lshrrev_b32 v34, 19, v52
    v_add_u32 v34, v34, v39
    ds_write_b32 v44, v32 offset:43032
    ds_write_b8 v45, v33 offset:49158
    ds_write_b32 v44, v34 offset:46104
    v_cmp_lt_i32 vcc, 7, v43
    s_mov_b64 exec, vcc
    s_cbranch_execz M_round_done
    v_and_b32 v32, 0x3fff, v53
    v_bfe_u32 v33, v53, 14, 5
    v_lshrrev_b32 v34, 19, v53
    v_add_u32 v34, v34, v39
    ds_write_b32 v44, v32 offset:43036
    ds_write_b8 v45, v33 offset:49159
    ds_write_b32 v44, v34 offset:46108
M_round_done:
    s_mov_b64 exec, -1
    v_subrev_u32 v43, 8, v43
    v_add_u32 v35, 32, v35
    v_add_u32 v44, 32, v44
    v_add_u32 v45, 8, v45
    v_cmp_lt_i32 vcc, 0, v43
    s_cbranch_vccnz M_round
    s_cmp_ge_u32 s32, 2
    s_cbranch_scc1 M_pad_dones
    v_add_u32 v32, s37, v0
    v_mov_b32 v34, 0xffffff
    v_lshlrev_b32 v33, 2, v32
    ds_write_b32 v33, v34 offset:43008
    ds_write_b32 v33, v34 offset:46080
    v_mov_b32 v34, 15
    ds_write_b8 v32, v34 offset:49152
M_pad_dones:
    v_lshrrev_b32 v32, 3, v1
    s_lshl_b32 s38, s32, 5
    v_lshlrev_b32 v32, 2, v32
    s_add_u32 s38, s38, 46080
    v_bfe_u32 v33, v1, 1, 3
    v_add_u32 v12, 43008, v32
    v_lshl_add_u32 v13, v33, 2, s38
    v_mov_b32 v14, v54
    s_branch M_lists_done
M_empty:
    v_lshrrev_b32 v27, 4, v0
    v_add_u32 v27, s33, v27
    v_lshlrev_b32 v27, 8, v27
    v_and_b32 v160, 15, v0
    v_lshl_add_u32 v27, v160, 4, v27
    buffer_load_dwordx4 v[160:163], v27, s[44:47], 0 offen
    s_waitcnt vmcnt(0)
    s_branch M_epilogue
M_last:
.section .rodata,"a"
.p2align 6
.amdhsa_kernel gather_scatter__edge_featured_mpnn_egc__graph_kernel
  .amdhsa_next_free_vgpr 164
  .amdhsa_next_free_sgpr 60
  .amdhsa_accum_offset 164
  .amdhsa_group_segment_fixed_size 0
  .amdhsa_kernarg_size 80
  .amdhsa_user_sgpr_count 2
  .amdhsa_user_sgpr_kernarg_segment_ptr 1
  .amdhsa_system_sgpr_workgroup_id_x 1
  .amdhsa_float_denorm_mode_32 3
.end_amdhsa_kernel
.text
```
